```python
import torch

def _softmax(x, axis=-1):
    return torch.softmax(x, dim=axis)
def _gelu(x):
    return torch.nn.functional.gelu(x, approximate="tanh")
def _silu(x):
    return torch.nn.functional.silu(x)
def _sigmoid(x):
    return torch.sigmoid(x)
def _layernorm(x, axis=-1, eps=1e-5):
    m = x.mean(dim=axis, keepdim=True)
    v = x.var(dim=axis, keepdim=True, unbiased=False)
    return (x - m) / torch.sqrt(v + eps)
def _scatter_add(tgt, idx, src, axis=0):
    return tgt.clone().index_add_(axis, idx, src)
def _segment_sum(src, seg, n):
    out = torch.zeros((n,) + src.shape[1:], dtype=src.dtype)
    return out.index_add_(0, seg, src)
def _pad(x, pw):
    flat = tuple(v for pair in reversed(pw) for v in pair)
    return torch.nn.functional.pad(x, flat)

kernel_name = 'gather_scatter__hybrid_graph_tf_nagphormer__graph'

def setup_inputs():

    _w = (lambda a: (lambda t: t.to(torch.bfloat16) if t.is_floating_point() else t)(torch.as_tensor(a)))
    N, deg, D = 10000, 32, 128
    E = N * deg
    src = (lambda lo, hi, *s: torch.randint(lo, hi, s))(0, N, E).to(torch.int64)
    dst = (lambda lo, hi, *s: torch.randint(lo, hi, s))(0, N, E).to(torch.int64)
    deg_cnt = torch.bincount(dst, minlength=N).to(float) + 1.0
    sc = 1.0 / D ** 0.5
    return {
        "x": _w((lambda *s: torch.randn(*s, dtype=torch.bfloat16) * 0.1)(N, D)),
        "src": _w(src),
        "dst": _w(dst),
        "deg_inv_sqrt": _w(1.0 / (lambda _x: torch.sqrt(torch.as_tensor(_x)))(deg_cnt)),
        "wq": _w((lambda *s: torch.randn(*s, dtype=torch.bfloat16) * 1.6)(D, D) * sc),
        "wk": _w((lambda *s: torch.randn(*s, dtype=torch.bfloat16) * 1.6)(D, D) * sc),
        "wv": _w((lambda *s: torch.randn(*s, dtype=torch.bfloat16) * 0.1)(D, D) * sc),
        "wo": _w((lambda *s: torch.randn(*s, dtype=torch.bfloat16) * 0.1)(D, D) * sc),
        "w_r": _w((lambda *s: torch.randn(*s, dtype=torch.bfloat16) * 0.1)(D)),
    }

def reference(x, src, dst, deg_inv_sqrt, wq, wk, wv, wo, w_r):
    N, D = x.shape[0], x.shape[1]
    K = 7
    h = x
    toks = [x]
    for _ in range(K):
        msg = h[src] * deg_inv_sqrt[src, None] * deg_inv_sqrt[dst, None]
        h = _segment_sum(msg, dst, N)
        toks.append(h)
    tok = torch.stack(toks, axis=1)
    t = _layernorm(tok, axis=-1)
    q   = torch.einsum('nkd,de->nke', t, wq)
    key = torch.einsum('nkd,de->nke', t, wk)
    v   = torch.einsum('nkd,de->nke', t, wv)
    scale = 1.0 / (D ** 0.5)
    attn = _softmax(torch.einsum('nkd,nld->nkl', q, key) * scale, axis=-1)
    o = torch.einsum('nkl,nld->nkd', attn, v)
    o = tok + torch.einsum('nkd,de->nke', o, wo)
    r = _layernorm(o, axis=-1)
    alpha = _softmax(torch.einsum('nkd,d->nk', r, w_r), axis=-1)
    return torch.einsum('nk,nkd->nd', alpha, o)
```

```asm
; @launch grid=(256,1,1) block=(768,1,1) lds=163840
.amdgcn_target "amdgcn-amd-amdhsa--gfx950"
.text
.globl gather_scatter__hybrid_graph_tf_nagphormer__graph_kernel
.p2align 8
.type gather_scatter__hybrid_graph_tf_nagphormer__graph_kernel,@function
gather_scatter__hybrid_graph_tf_nagphormer__graph_kernel:
    s_cmp_ge_u32 s2, 256
    s_cbranch_scc1 k_end
    s_load_dwordx2 s[4:5], s[0:1], 88
    s_load_dwordx4 s[40:43], s[0:1], 0
    s_load_dwordx4 s[44:47], s[0:1], 16
    v_mov_b32 v48, v0
    v_lshrrev_b32 v3, 6, v0
    v_and_b32 v16, 63, v0
    v_readfirstlane_b32 s6, v3
    v_lshlrev_b32 v2, 4, v16
    s_mov_b32 s19, 0
    s_cmp_lt_u32 s2, 128
    s_cbranch_scc0 k_np
    s_lshl_b32 s3, s2, 7
    v_lshrrev_b32 v49, 3, v48
    v_lshlrev_b32 v52, 14, v49
    v_and_b32 v50, 7, v48
    v_lshl_add_u32 v52, v50, 4, v52
    v_add_u32 v52, s3, v52
    s_mov_b32 s66, 1280000
    s_mov_b32 s67, 0x20000
    s_mov_b32 s70, 1280000
    s_mov_b32 s71, 0x20000
    v_mov_b32 v51, 0
    v_lshlrev_b32 v53, 2, v48
    s_waitcnt lgkmcnt(0)
    s_mov_b32 s64, s42
    s_mov_b32 s65, s43
    s_mov_b32 s68, s44
    s_mov_b32 s69, s45
    buffer_load_dwordx4 v[64:67], v52, s[68:71], 0 offen
    buffer_load_dwordx4 v[56:59], v52, s[64:67], 0 offen
    ds_write_b32 v53, v51 offset:49152
    v_lshlrev_b32 v53, 4, v48
    v_mov_b32 v80, -1
    v_mov_b32 v81, -1
    v_mov_b32 v82, -1
    v_mov_b32 v83, -1
    ds_write_b128 v53, v[80:83]
    ds_write_b128 v53, v[80:83] offset:12288
    ds_write_b128 v53, v[80:83] offset:24576
    ds_write_b128 v53, v[80:83] offset:36864
    s_load_dword s98, s[4:5], 0
    s_lshr_b32 s7, s2, 5
    s_and_b32 s8, s2, 7
    s_lshl_b32 s8, s8, 2
    s_bfe_u32 s3, s2, 0x20003
    s_add_u32 s8, s8, s3
    s_lshl_b32 s11, s6, 3
    s_add_u32 s11, s11, s7
    s_lshl_b32 s27, s11, 7
    v_lshl_add_u32 v17, v16, 1, s27
    v_add_u32 v18, 10240, v17
    s_mov_b32 s44, s46
    s_mov_b32 s45, s47
    s_mov_b32 s46, 20000
    s_mov_b32 s47, 0x20000
    buffer_load_ushort v13, v17, s[44:47], 0 offen
    buffer_load_ushort v14, v18, s[44:47], 0 offen
    v_cmp_gt_u32 vcc, 1280000, v52
    s_mov_b32 s77, 0x3fffff
    v_mov_b32 v51, 1
    s_mov_b64 s[74:75], vcc
    s_movk_i32 s73, 5120
    s_movk_i32 s72, 10240
    v_mov_b32 v78, 0x80000
    v_lshlrev_b32 v53, 2, v49
    v_lshlrev_b32 v54, 8, v49
    v_lshl_add_u32 v54, v50, 4, v54
    v_lshlrev_b32 v55, 15, v49
    v_lshl_add_u32 v55, v50, 4, v55
    v_mov_b32 v50, 0
    s_mov_b32 s78, 0
    s_lshl_b32 s3, s2, 8
    s_add_u32 s64, s4, 28311552
    s_addc_u32 s65, s5, 0
    s_mov_b32 s66, 5144576
    s_add_u32 s76, s3, 3145728
    v_mov_b32 v79, 50176
    s_waitcnt lgkmcnt(0)
    s_mul_i32 s53, s98, 0x9E3779B1
    s_lshr_b32 s27, s53, 15
    s_xor_b32 s53, s53, s27
    s_mul_i32 s53, s53, 0x85EBCA6B
    s_add_u32 s53, s53, 0x632BE5AB
    s_barrier
    s_mov_b64 exec, s[74:75]
    s_waitcnt vmcnt(3)
    v_lshrrev_b32 v68, 6, v64
    v_lshlrev_b32 v76, 2, v68
    ds_add_rtn_u32 v72, v76, v51 offset:49152
    v_lshrrev_b32 v69, 6, v65
    v_lshlrev_b32 v76, 2, v69
    ds_add_rtn_u32 v73, v76, v51 offset:49152
    v_lshrrev_b32 v70, 6, v66
    v_lshlrev_b32 v76, 2, v70
    ds_add_rtn_u32 v74, v76, v51 offset:49152
    v_lshrrev_b32 v71, 6, v67
    v_lshlrev_b32 v76, 2, v71
    ds_add_rtn_u32 v75, v76, v51 offset:49152
    s_waitcnt vmcnt(2)
    v_subrev_u32 v76, s73, v56
    v_add_u32 v56, s72, v56
    v_min_u32 v56, v56, v76
    v_lshl_or_b32 v56, v64, 16, v56
    v_lshlrev_b32 v68, 8, v68
    v_subrev_u32 v76, s73, v57
    v_add_u32 v57, s72, v57
    v_min_u32 v57, v57, v76
    v_lshl_or_b32 v57, v65, 16, v57
    v_lshlrev_b32 v69, 8, v69
    v_subrev_u32 v76, s73, v58
    v_add_u32 v58, s72, v58
    v_min_u32 v58, v58, v76
    v_lshl_or_b32 v58, v66, 16, v58
    v_lshlrev_b32 v70, 8, v70
    v_subrev_u32 v76, s73, v59
    v_add_u32 v59, s72, v59
    v_min_u32 v59, v59, v76
    v_lshl_or_b32 v59, v67, 16, v59
    v_lshlrev_b32 v71, 8, v71
    s_waitcnt lgkmcnt(0)
    v_max3_u32 v77, v72, v73, v74
    v_max_u32 v77, v77, v75
    v_lshl_add_u32 v76, v72, 2, v68
    v_cmp_gt_u32 vcc, 56, v72
    v_and_b32 v84, s77, v56
    s_nop 0
    v_cndmask_b32 v76, v78, v76, vcc
    ds_write_b32 v76, v84
    v_lshl_add_u32 v76, v73, 2, v69
    v_cmp_gt_u32 vcc, 56, v73
    v_and_b32 v84, s77, v57
    s_nop 0
    v_cndmask_b32 v76, v78, v76, vcc
    ds_write_b32 v76, v84
    v_lshl_add_u32 v76, v74, 2, v70
    v_cmp_gt_u32 vcc, 56, v74
    v_and_b32 v84, s77, v58
    s_nop 0
    v_cndmask_b32 v76, v78, v76, vcc
    ds_write_b32 v76, v84
    v_lshl_add_u32 v76, v75, 2, v71
    v_cmp_gt_u32 vcc, 56, v75
    v_and_b32 v84, s77, v59
    s_nop 0
    v_cndmask_b32 v76, v78, v76, vcc
    ds_write_b32 v76, v84
    v_cmp_le_u32 vcc, 56, v77
    s_cbranch_vccnz ovf_1
ovb_2:
    s_mov_b64 exec, -1
    s_waitcnt lgkmcnt(0)
    s_barrier
    ds_read_b32 v68, v53 offset:49152
    ds_read_b32 v69, v53 offset:49536
    ds_read_b32 v75, v79
cp_3:
    ds_read_b128 v[56:59], v54
    ds_read_b128 v[60:63], v54 offset:24576
    s_waitcnt lgkmcnt(1)
    v_cmp_le_u32 vcc, v50, v68
    s_nop 0
    s_mov_b64 exec, vcc
    buffer_store_dwordx4 v[56:59], v55, s[64:67], s3 offen sc1
    s_mov_b64 exec, -1
    s_waitcnt lgkmcnt(0)
    v_cmp_le_u32 vcc, v50, v69
    s_nop 0
    s_mov_b64 exec, vcc
    buffer_store_dwordx4 v[60:63], v55, s[64:67], s76 offen sc1
    s_mov_b64 exec, -1
    s_cmp_lg_u32 s78, 0
    s_cbranch_scc1 ce_4
    v_max_u32 v70, v68, v69
    v_cmp_le_u32 vcc, 32, v70
    s_cbranch_vccz ce_4
    s_mov_b32 s78, 1
    v_add_u32 v50, 32, v50
    v_add_u32 v54, 128, v54
    v_add_u32 v55, 128, v55
    s_branch cp_3
ce_4:
    s_lshl_b32 s3, s2, 7
    s_add_u32 s3, s3, 4096
    v_mov_b32 v73, s3
    v_mov_b32 v74, s53
    s_waitcnt vmcnt(0)
    s_barrier
    s_cmp_eq_u32 s6, 0
    s_cbranch_scc0 sk_5
    s_mov_b64 exec, 1
    global_store_dwordx2 v73, v[74:75], s[4:5] sc1
    s_mov_b64 exec, -1
sk_5:
    s_branch k_h0
k_np:
    s_cmp_ge_u32 s2, 253
    s_cbranch_scc1 k_w
    v_and_b32 v50, 15, v16
    v_lshrrev_b32 v51, 4, v16
    s_sub_u32 s60, s2, 128
    s_mul_i32 s68, s60, 80
    s_lshr_b32 s69, s6, 1
    s_lshl_b32 s69, s69, 4
    s_add_u32 s68, s68, s69
    s_and_b32 s69, s6, 1
    v_add_u32 v50, s68, v50
    v_lshlrev_b32 v52, 8, v50
    v_lshl_add_u32 v52, v51, 4, v52
    s_lshl_b32 s70, s69, 7
    v_lshlrev_b32 v53, 1, v50
    s_waitcnt lgkmcnt(0)
    s_mov_b32 s42, 2560000
    s_mov_b32 s43, 0x20000
    s_cmp_ge_u32 s6, 10
    s_cbranch_scc1 rs_6_a
    buffer_load_dwordx4 v[56:59], v52, s[40:43], s70 offen
    buffer_load_dwordx4 v[60:63], v52, s[40:43], s70 offen offset:64
rs_6_a:
    s_load_dword s98, s[4:5], 0
    s_lshr_b32 s7, s2, 5
    s_and_b32 s8, s2, 7
    s_lshl_b32 s8, s8, 2
    s_bfe_u32 s3, s2, 0x20003
    s_add_u32 s8, s8, s3
    s_lshl_b32 s11, s6, 3
    s_add_u32 s11, s11, s7
    s_lshl_b32 s27, s11, 7
    v_lshl_add_u32 v17, v16, 1, s27
    v_add_u32 v18, 10240, v17
    s_mov_b32 s44, s46
    s_mov_b32 s45, s47
    s_mov_b32 s46, 20000
    s_mov_b32 s47, 0x20000
    buffer_load_ushort v13, v17, s[44:47], 0 offen
    buffer_load_ushort v14, v18, s[44:47], 0 offen
    s_cmp_ge_u32 s6, 10
    s_cbranch_scc0 sk_7
    s_getpc_b64 s[16:17]
k_pc:
    s_sub_u32 s27, s2, 128
    s_lshr_b32 s27, s27, 3
    s_lshl_b32 s27, s27, 1
    s_add_u32 s27, s27, s6
    s_sub_u32 s27, s27, 10
    s_lshl_b32 s27, s27, 10
    s_min_u32 s27, s27, k_end-k_pc-1024
    s_add_u32 s16, s16, s27
    s_addc_u32 s17, s17, 0
    global_load_dwordx4 v[28:31], v2, s[16:17]
sk_7:
    s_waitcnt lgkmcnt(0)
    s_mul_i32 s53, s98, 0x9E3779B1
    s_lshr_b32 s27, s53, 15
    s_xor_b32 s53, s53, s27
    s_mul_i32 s53, s53, 0x85EBCA6B
    s_add_u32 s53, s53, 0x632BE5AB
    s_cmp_ge_u32 s6, 10
    s_cbranch_scc1 rs_6
    buffer_load_ushort v54, v53, s[44:47], 0 offen
    v_and_b32 v68, 1, v50
    v_lshl_add_u32 v55, v51, 1, v68
    s_mov_b32 s71, 81920
    v_mul_lo_u32 v55, v55, s71
    v_and_b32 v69, -2, v50
    v_lshl_add_u32 v55, v69, 3, v55
    v_cmp_eq_u32 vcc, 1, v68
    s_mul_i32 s70, s69, 1310720
    s_add_u32 s72, s4, s70
    s_addc_u32 s73, s5, 0
    s_add_u32 s72, s72, 2097152
    s_addc_u32 s73, s73, 0
    s_add_u32 s74, s72, 655360
    s_addc_u32 s75, s73, 0
    s_mov_b32 s71, 0xffff0000
    s_waitcnt vmcnt(0)
    v_lshlrev_b32 v54, 16, v54
    v_lshlrev_b32 v64, 16, v56
    v_and_b32 v65, s71, v56
    v_mul_f32 v64, v64, v54
    v_mul_f32 v65, v65, v54
    v_cvt_pk_bf16_f32 v56, v64, v65
    v_lshlrev_b32 v64, 16, v57
    v_and_b32 v65, s71, v57
    v_mul_f32 v64, v64, v54
    v_mul_f32 v65, v65, v54
    v_cvt_pk_bf16_f32 v57, v64, v65
    v_lshlrev_b32 v64, 16, v58
    v_and_b32 v65, s71, v58
    v_mul_f32 v64, v64, v54
    v_mul_f32 v65, v65, v54
    v_cvt_pk_bf16_f32 v58, v64, v65
    v_lshlrev_b32 v64, 16, v59
    v_and_b32 v65, s71, v59
    v_mul_f32 v64, v64, v54
    v_mul_f32 v65, v65, v54
    v_cvt_pk_bf16_f32 v59, v64, v65
    v_mov_b32_dpp v72, v58 quad_perm:[1,0,3,2] row_mask:0xf bank_mask:0xf
    s_nop 0
    v_mov_b32_dpp v73, v59 quad_perm:[1,0,3,2] row_mask:0xf bank_mask:0xf
    v_mov_b32_dpp v74, v56 quad_perm:[1,0,3,2] row_mask:0xf bank_mask:0xf
    v_mov_b32_dpp v75, v57 quad_perm:[1,0,3,2] row_mask:0xf bank_mask:0xf
    v_cndmask_b32 v56, v56, v72, vcc
    v_cndmask_b32 v57, v57, v73, vcc
    v_cndmask_b32 v58, v74, v58, vcc
    v_cndmask_b32 v59, v75, v59, vcc
    global_store_dwordx4 v55, v[56:59], s[72:73] sc1
    v_lshlrev_b32 v64, 16, v60
    v_and_b32 v65, s71, v60
    v_mul_f32 v64, v64, v54
    v_mul_f32 v65, v65, v54
    v_cvt_pk_bf16_f32 v60, v64, v65
    v_lshlrev_b32 v64, 16, v61
    v_and_b32 v65, s71, v61
    v_mul_f32 v64, v64, v54
    v_mul_f32 v65, v65, v54
    v_cvt_pk_bf16_f32 v61, v64, v65
    v_lshlrev_b32 v64, 16, v62
    v_and_b32 v65, s71, v62
    v_mul_f32 v64, v64, v54
    v_mul_f32 v65, v65, v54
    v_cvt_pk_bf16_f32 v62, v64, v65
    v_lshlrev_b32 v64, 16, v63
    v_and_b32 v65, s71, v63
    v_mul_f32 v64, v64, v54
    v_mul_f32 v65, v65, v54
    v_cvt_pk_bf16_f32 v63, v64, v65
    v_mov_b32_dpp v72, v62 quad_perm:[1,0,3,2] row_mask:0xf bank_mask:0xf
    s_nop 0
    v_mov_b32_dpp v73, v63 quad_perm:[1,0,3,2] row_mask:0xf bank_mask:0xf
    v_mov_b32_dpp v74, v60 quad_perm:[1,0,3,2] row_mask:0xf bank_mask:0xf
    v_mov_b32_dpp v75, v61 quad_perm:[1,0,3,2] row_mask:0xf bank_mask:0xf
    v_cndmask_b32 v60, v60, v72, vcc
    v_cndmask_b32 v61, v61, v73, vcc
    v_cndmask_b32 v62, v74, v62, vcc
    v_cndmask_b32 v63, v75, v63, vcc
    global_store_dwordx4 v55, v[60:63], s[74:75] sc1
rs_6:
    s_lshl_b32 s3, s60, 7
    s_add_u32 s3, s3, 20480
    v_mov_b32 v73, s3
    v_mov_b32 v74, s53
    s_waitcnt vmcnt(0)
    s_barrier
    s_cmp_eq_u32 s6, 0
    s_cbranch_scc0 sk_8
    s_mov_b64 exec, 1
    global_store_dword v73, v74, s[4:5] sc1
    s_mov_b64 exec, -1
sk_8:
k_h0:
    s_cmp_eq_u32 s6, 11
    s_cbranch_scc0 sk_9
    s_getreg_b32 s27, hwreg(HW_REG_XCC_ID)
    s_and_b32 s27, s27, 15
    s_add_u32 s27, s27, s53
    v_mov_b32 v21, s27
    s_lshl_b32 s27, s8, 3
    s_add_u32 s27, s27, s7
    s_lshl_b32 s27, s27, 7
    s_add_u32 s27, s27, 122880
    v_mov_b32 v20, s27
    s_mov_b64 exec, 1
    global_store_dword v20, v21, s[4:5] sc1
    s_mov_b64 exec, -1
sk_9:
k_h1:
    v_lshlrev_b32 v52, 4, v48
    v_cmp_gt_u32 vcc, 576, v48
    s_nop 1
    v_cndmask_b32 v64, 0, -1, vcc
    v_mov_b32 v65, v64
    v_mov_b32 v66, v64
    v_mov_b32 v67, v64
    ds_write_b128 v52, v[64:67] offset:40960
    s_mov_b32 s22, 0x55555555
    s_mov_b32 s23, 0x55555555
    s_lshl_b32 s27, s11, 9
    v_lshl_add_u32 v0, v16, 3, s27
    s_mul_i32 s27, s8, 81920
    s_add_u32 s12, s4, s27
    s_addc_u32 s13, s5, 0
    s_add_u32 s12, s12, 2097152
    s_addc_u32 s13, s13, 0
    s_add_u32 s14, s12, 7864320
    s_addc_u32 s15, s13, 0
    s_lshl_b32 s27, s8, 10
    s_and_b32 s30, s6, 1
    s_lshl_b32 s30, s30, 9
    s_add_u32 s27, s27, s30
    s_add_u32 s36, s4, s27
    s_addc_u32 s37, s5, 0
    s_add_u32 s36, s36, 262144
    s_addc_u32 s37, s37, 0
    s_lshr_b32 s27, s6, 1
    s_lshl_b32 s27, s27, 3
    s_add_u32 s27, s27, s7
    s_lshl_b32 s27, s27, 2
    s_add_u32 s38, s36, s27
    s_addc_u32 s39, s37, 0
    v_bfe_u32 v40, v16, 4, 1
    v_bfe_u32 v41, v16, 3, 1
    v_bfe_u32 v42, v16, 2, 1
    v_mov_b32 v43, 0x3f80
    v_cmp_eq_u32 vcc, v40, v41
    s_nop 1
    v_cndmask_b32 v43, 0, v43, vcc
    v_cmp_eq_u32 vcc, 0, v42
    s_nop 1
    v_cndmask_b32 v8, 0, v43, vcc
    v_cndmask_b32 v9, 0, v43, vcc
    v_cndmask_b32 v10, v43, 0, vcc
    v_cndmask_b32 v11, v43, 0, vcc
    v_and_b32 v40, 3, v16
    v_add_u32 v41, 1, v40
    v_and_b32 v41, 3, v41
    v_lshl_or_b32 v40, v41, 2, v40
    s_mov_b32 s27, 0x11111111
    v_mul_lo_u32 v12, v40, s27
    s_mov_b32 s18, 0
    s_mov_b32 s24, 0
    v_lshlrev_b32 v40, 3, v2
    v_add_u32 v40, 20480, v40
    v_add_u32 v41, 7808, v40
    s_lshl_b32 s42, s6, 10
    v_add_u32 v23, s42, v2
    s_sub_u32 s27, s2, 97
    s_cmp_lt_u32 s27, 157
    s_cbranch_scc0 k_nb
    s_sub_u32 s89, s2, 97
    s_lshl_b32 s3, s89, 15
    s_add_u32 s60, s4, s3
    s_addc_u32 s61, s5, 0
    s_add_u32 s60, s60, 28311552
    s_addc_u32 s61, s61, 0
    s_mov_b32 s3, 0xAAAB
    v_mul_u32_u24 v49, s3, v48
    v_lshrrev_b32 v49, 18, v49
    v_mul_u32_u24 v50, 6, v49
    v_sub_u32 v50, v48, v50
    v_lshlrev_b32 v49, 8, v49
    v_lshl_add_u32 v51, v50, 4, v49
    v_cmp_gt_u32 s[62:63], 2, v50
    v_cmp_eq_u32 s[66:67], 1, v50
    s_movk_i32 s64, 5120
    s_cmp_lt_u32 s89, 80
    s_cselect_b32 s68, s64, 0
    s_movk_i32 s65, 72
    v_mov_b32 v53, 1
    v_mov_b32 v54, 0
    v_mov_b32 v52, 1
    v_mov_b32 v55, 51712
    v_mov_b32 v60, -1
    v_mov_b32 v61, -1
    v_mov_b32 v62, -1
    v_mov_b32 v63, -1
    v_lshlrev_b32 v68, 3, v2
    v_add_u32 v68, 4096, v68
    v_add_u32 v69, 8192, v68
    v_mov_b32 v53, 0
    v_mov_b32 v94, 0x80000
    s_cmp_eq_u32 s6, 0
    s_cbranch_scc0 sk_10
    s_branch se_13
sp_11:
    s_sleep 1
se_13:
    global_load_dwordx2 v[70:71], v68, s[4:5] sc1
    global_load_dwordx2 v[72:73], v69, s[4:5] sc1
    s_add_u32 s19, s19, 1
    s_cmp_ge_u32 s19, 4194304
    s_cbranch_scc1 so_12
    s_waitcnt vmcnt(0)
    v_xor_b32 v74, s53, v70
    v_xor_b32 v75, s53, v72
    v_or_b32 v74, v74, v75
    v_cmp_ne_u32 vcc, 0, v74
    s_cbranch_vccnz sp_11
so_12:
    s_waitcnt vmcnt(0)
    v_or_b32 v71, v71, v73
    v_cmp_ne_u32 vcc, 0, v71
    s_nop 0
    s_cmp_lg_u64 vcc, 0
    s_cselect_b32 s90, 0x800000, 0
sk_10:
    s_cmp_eq_u32 s6, 11
    s_cbranch_scc0 sk_14
    s_branch se_17
sp_15:
    s_sleep 1
se_17:
    global_load_dword v42, v40, s[4:5] sc1
    global_load_dword v43, v41, s[4:5] sc1
    s_add_u32 s19, s19, 1
    s_cmp_ge_u32 s19, 4194304
    s_cbranch_scc1 so_16
    s_waitcnt vmcnt(0)
    v_xor_b32 v42, s53, v42
    v_xor_b32 v43, s53, v43
    v_or_b32 v42, v42, v43
    v_cmp_ne_u32 vcc, 0, v42
    s_cbranch_vccnz sp_15
so_16:
    s_waitcnt vmcnt(0)
sk_14:
    s_cmp_eq_u32 s6, 10
    s_cbranch_scc0 sk_18
    v_lshlrev_b32 v32, 3, v2
    s_lshl_b32 s27, s8, 10
    s_add_u32 s27, s27, 122880
    v_add_u32 v32, s27, v32
    s_mov_b64 exec, 0xff
    s_branch se_21
sp_19:
    s_sleep 8
se_21:
    global_load_dword v33, v32, s[4:5] sc1
    s_add_u32 s19, s19, 1
    s_cmp_ge_u32 s19, 4194304
    s_cbranch_scc1 so_20
    s_waitcnt vmcnt(0)
    v_subrev_u32 v34, s53, v33
    v_cmp_le_u32 vcc, 16, v34
    s_cbranch_vccnz sp_19
so_20:
    s_waitcnt vmcnt(0)
    v_readfirstlane_b32 s27, v33
    s_nop 1
    v_cmp_ne_u32 vcc, s27, v33
    s_mov_b64 exec, 1
    s_cmp_eq_u64 vcc, 0
    s_cselect_b32 s27, 1, 0
    v_mov_b32 v36, s27
    v_mov_b32 v37, 0
    v_mov_b32 v38, 0
    v_mov_b32 v39, 0
    ds_write_b128 v2, v[36:39] offset:39936
    s_mov_b64 exec, -1
sk_18:
    s_waitcnt lgkmcnt(0)
    s_barrier
    global_load_dwordx4 v[56:59], v51, s[60:61] sc1
    s_mov_b64 exec, s[62:63]
    global_load_dwordx4 v[60:63], v51, s[60:61] offset:96 sc1
    s_mov_b64 exec, -1
    s_cmp_eq_u32 s6, 0
    s_cbranch_scc0 sk_22
    v_mov_b32 v68, s90
    s_mov_b64 exec, 1
    ds_or_b32 v55, v68 offset:4
    s_mov_b64 exec, -1
sk_22:
    s_waitcnt vmcnt(0)
    v_cmp_gt_u16 s[72:73], s64, v56
    v_lshrrev_b32 v64, 16, v56
    v_cmp_gt_u16 s[74:75], s64, v57
    v_lshrrev_b32 v65, 16, v57
    v_cmp_gt_u16 s[76:77], s64, v58
    v_lshrrev_b32 v66, 16, v58
    v_cmp_gt_u16 s[78:79], s64, v59
    v_lshrrev_b32 v67, 16, v59
    v_sub_u32 v68, v56, v64
    v_cndmask_b32 v84, 0, 12, s[72:73]
    v_sub_u32 v69, v57, v65
    v_cndmask_b32 v85, 0, 12, s[74:75]
    v_sub_u32 v70, v58, v66
    v_cndmask_b32 v86, 0, 12, s[76:77]
    v_sub_u32 v71, v59, v67
    v_cndmask_b32 v87, 0, 12, s[78:79]
    v_lshlrev_b32 v76, v68, v52
    v_sub_u32 v68, v68, v84
    v_lshlrev_b32 v77, v69, v52
    v_sub_u32 v69, v69, v85
    v_lshlrev_b32 v78, v70, v52
    v_sub_u32 v70, v70, v86
    v_lshlrev_b32 v79, v71, v52
    v_sub_u32 v71, v71, v87
    v_and_b32 v68, 31, v68
    v_lshlrev_b32 v72, 3, v64
    v_and_b32 v69, 31, v69
    v_lshlrev_b32 v73, 3, v65
    v_and_b32 v70, 31, v70
    v_lshlrev_b32 v74, 3, v66
    v_and_b32 v71, 31, v71
    v_lshlrev_b32 v75, 3, v67
    v_add_u32 v68, v68, v84
    v_mov_b32 v80, 0
    v_add_u32 v69, v69, v85
    v_mov_b32 v81, 0
    v_add_u32 v70, v70, v86
    v_mov_b32 v82, 0
    v_add_u32 v71, v71, v87
    v_mov_b32 v83, 0
    v_lshrrev_b32 v84, 5, v68
    v_lshrrev_b32 v85, 5, v69
    v_lshrrev_b32 v86, 5, v70
    v_lshrrev_b32 v87, 5, v71
    v_cmp_ne_u32 s[70:71], -1, v60
    v_lshl_add_u32 v84, v84, 2, v72
    v_lshl_add_u32 v85, v85, 2, v73
    v_lshl_add_u32 v86, v86, 2, v74
    v_lshl_add_u32 v87, v87, 2, v75
    v_cmpx_ne_u32 vcc, -1, v56
    ds_or_rtn_b32 v80, v84, v76 offset:50176
    v_cmpx_ne_u32 vcc, -1, v57
    ds_or_rtn_b32 v81, v85, v77 offset:50176
    v_cmpx_ne_u32 vcc, -1, v58
    ds_or_rtn_b32 v82, v86, v78 offset:50176
    v_cmpx_ne_u32 vcc, -1, v59
    ds_or_rtn_b32 v83, v87, v79 offset:50176
    s_mov_b64 exec, -1
    s_cmp_lg_u64 s[70:71], 0
    s_cbranch_scc1 lt_23
ltb_24:
    v_min_u32 v64, 0xe00, v64
    v_min_u32 v65, 0xe00, v65
    v_min_u32 v66, 0xe00, v66
    v_min_u32 v67, 0xe00, v67
    v_mad_u32_u24 v64, v64, s65, v68
    v_mad_u32_u24 v65, v65, s65, v69
    v_mad_u32_u24 v66, v66, s65, v70
    v_mad_u32_u24 v67, v67, s65, v71
    v_lshlrev_b32 v64, 1, v64
    v_lshlrev_b32 v65, 1, v65
    v_lshlrev_b32 v66, 1, v66
    v_lshlrev_b32 v67, 1, v67
    s_add_u32 m0, s42, 81920
    s_add_u32 s16, s12, 0
    s_addc_u32 s17, s13, 0
    global_load_lds_dwordx4 v23, s[16:17] sc1
    s_add_u32 m0, s42, 94208
    s_add_u32 s16, s12, 12288
    s_addc_u32 s17, s13, 0
    global_load_lds_dwordx4 v23, s[16:17] sc1
    s_waitcnt lgkmcnt(3)
    v_and_b32 v80, v80, v76
    v_cmp_ne_u32 s[80:81], 0, v80
    s_waitcnt lgkmcnt(2)
    v_and_b32 v81, v81, v77
    v_cmp_ne_u32 s[82:83], 0, v81
    s_waitcnt lgkmcnt(1)
    v_and_b32 v82, v82, v78
    v_cmp_ne_u32 s[84:85], 0, v82
    s_waitcnt lgkmcnt(0)
    v_and_b32 v83, v83, v79
    v_cmp_ne_u32 s[86:87], 0, v83
    v_mbcnt_lo_u32_b32 v88, s80, 0
    v_mbcnt_hi_u32_b32 v88, s81, v88
    v_mbcnt_lo_u32_b32 v88, s82, v88
    v_mbcnt_hi_u32_b32 v88, s83, v88
    v_mbcnt_lo_u32_b32 v88, s84, v88
    v_mbcnt_hi_u32_b32 v88, s85, v88
    v_mbcnt_lo_u32_b32 v88, s86, v88
    v_mbcnt_hi_u32_b32 v88, s87, v88
    v_addc_co_u32 v89, vcc, 0, v88, s[80:81]
    v_addc_co_u32 v90, vcc, 0, v89, s[82:83]
    v_addc_co_u32 v91, vcc, 0, v90, s[84:85]
    v_addc_co_u32 v92, vcc, 0, v91, s[86:87]
    s_mov_b32 exec_lo, 0
    s_brev_b32 exec_hi, 1
    ds_add_rtn_u32 v93, v55, v92
    s_mov_b64 exec, -1
    v_cndmask_b32 v64, v64, v94, s[80:81]
    ds_write_b16 v64, v56 offset:40960
    v_cndmask_b32 v65, v65, v94, s[82:83]
    ds_write_b16 v65, v57 offset:40960
    v_cndmask_b32 v66, v66, v94, s[84:85]
    ds_write_b16 v66, v58 offset:40960
    v_cndmask_b32 v67, v67, v94, s[86:87]
    ds_write_b16 v67, v59 offset:40960
    s_mov_b64 exec, s[80:81]
    ds_add_u32 v72, v52 offset:51200
    s_mov_b64 exec, s[82:83]
    ds_add_u32 v73, v52 offset:51200
    s_mov_b64 exec, s[84:85]
    ds_add_u32 v74, v52 offset:51200
    s_mov_b64 exec, s[86:87]
    ds_add_u32 v75, v52 offset:51200
    s_mov_b64 exec, -1
    s_waitcnt lgkmcnt(8)
    v_readlane_b32 s70, v93, 63
    s_nop 1
    v_add_lshl_u32 v88, v88, s70, 2
    v_add_lshl_u32 v89, v89, s70, 2
    v_add_lshl_u32 v90, v90, s70, 2
    v_add_lshl_u32 v91, v91, s70, 2
    v_cndmask_b32 v88, v94, v88, s[80:81]
    ds_write_b32 v88, v56 offset:51840
    v_cndmask_b32 v89, v94, v89, s[82:83]
    ds_write_b32 v89, v57 offset:51840
    v_cndmask_b32 v90, v94, v90, s[84:85]
    ds_write_b32 v90, v58 offset:51840
    v_cndmask_b32 v91, v94, v91, s[86:87]
    ds_write_b32 v91, v59 offset:51840
    s_add_u32 m0, s42, 106496
    s_add_u32 s16, s12, 24576
    s_addc_u32 s17, s13, 0
    global_load_lds_dwordx4 v23, s[16:17] sc1
    s_cmp_lt_u32 s6, 4
    s_cselect_b32 s27, 122880, 0
    s_add_u32 s27, s27, s42
    s_sub_u32 m0, s27, 4096
    s_add_u32 s16, s12, 36864
    s_addc_u32 s17, s13, 0
    global_load_lds_dwordx4 v23, s[16:17] sc1
    s_add_u32 m0, s42, 8192
    s_add_u32 s16, s12, 49152
    s_addc_u32 s17, s13, 0
    global_load_lds_dwordx4 v23, s[16:17] sc1
    s_waitcnt lgkmcnt(0)
    s_barrier
    v_lshrrev_b32 v50, 1, v2
    ds_read_b64 v[64:65], v50 offset:50176
    ds_read_b32 v51, v50 offset:51200
    ds_read_b32 v49, v55
    v_lshlrev_b32 v54, 2, v48
    ds_read_b32 v56, v54 offset:51840
    v_subrev_u32 v68, s6, v16
    v_mov_b32 v66, 0
    v_mov_b32 v67, 0
    s_mov_b32 s3, 0x9E3779
    v_mul_u32_u24 v88, s3, v48
    s_mov_b32 s88, 0x41C64D
    v_mov_b32 v89, 12345
    s_waitcnt lgkmcnt(3)
    v_lshrrev_b64 v[70:71], s6, v[64:65]
    v_bfe_u32 v72, v70, 0, 1
    v_bfi_b32 v73, 31, v68, v16
    v_cmp_ne_u32 vcc, 0, v72
    v_add_u32 v68, -12, v68
    s_nop 0
    v_lshrrev_b64 v[74:75], v73, vcc
    v_and_b32 v74, 1, v74
    v_lshl_or_b32 v66, v74, 0, v66
    v_bfe_u32 v72, v70, 12, 1
    v_bfi_b32 v73, 31, v68, v16
    v_cmp_ne_u32 vcc, 0, v72
    v_add_u32 v68, -12, v68
    s_nop 0
    v_lshrrev_b64 v[74:75], v73, vcc
    v_and_b32 v74, 1, v74
    v_lshl_or_b32 v66, v74, 12, v66
    v_bfe_u32 v72, v70, 24, 1
    v_bfi_b32 v73, 31, v68, v16
    v_cmp_ne_u32 vcc, 0, v72
    v_add_u32 v68, -12, v68
    s_nop 0
    v_lshrrev_b64 v[74:75], v73, vcc
    v_and_b32 v74, 1, v74
    v_lshl_or_b32 v66, v74, 24, v66
    v_bfe_u32 v72, v71, 4, 1
    v_bfi_b32 v73, 31, v68, v16
    v_cmp_ne_u32 vcc, 0, v72
    s_nop 1
    v_lshrrev_b64 v[74:75], v73, vcc
    v_and_b32 v74, 1, v74
    v_lshl_or_b32 v67, v74, 4, v67
    v_lshlrev_b64 v[66:67], s6, v[66:67]
    ds_or_b64 v50, v[66:67] offset:50688
    s_waitcnt lgkmcnt(1)
    v_readfirstlane_b32 s71, v49
    v_bcnt_u32_b32 v51, v64, v51
    v_bcnt_u32_b32 v51, v65, v51
    v_bfe_u32 v62, v56, 16, 6
    v_lshlrev_b32 v57, 3, v62
    v_bfi_b32 v58, 31, v56, v62
    v_lshlrev_b32 v58, 3, v58
    v_cmp_gt_u32 s[86:87], s71, v48
    ds_read_b64 v[64:65], v57 offset:50176
    v_mul_u32_u24 v62, 144, v62
    v_cmp_gt_u16 vcc, s68, v56
    v_mov_b32 v61, 0xfffff000
    v_mov_b32 v63, 0x10000
    v_cndmask_b32 v59, -1, v61, vcc
    v_cndmask_b32 v61, v63, 1, vcc
    s_waitcnt lgkmcnt(0)
    s_barrier
    ds_read_b64 v[66:67], v58 offset:50688
    s_add_u32 m0, s42, 20480
    s_add_u32 s16, s12, 61440
    s_addc_u32 s17, s13, 0
    global_load_lds_dwordx4 v23, s[16:17] sc1
    s_add_u32 m0, s42, 32768
    s_add_u32 s16, s12, 73728
    s_addc_u32 s17, s13, 0
    s_cmp_lt_u32 s6, 7
    s_cbranch_scc0 sk_25
    global_load_lds_dwordx4 v23, s[16:17] sc1
sk_25:
    v_max_u32_dpp v51, v51, v51 row_ror:8 row_mask:0xf bank_mask:0xf
    s_nop 1
    v_max_u32_dpp v51, v51, v51 row_ror:4 row_mask:0xf bank_mask:0xf
    s_nop 1
    v_max_u32_dpp v51, v51, v51 row_ror:2 row_mask:0xf bank_mask:0xf
    s_nop 1
    v_max_u32_dpp v51, v51, v51 row_ror:1 row_mask:0xf bank_mask:0xf
    s_nop 0
    v_readlane_b32 s72, v51, 0
    v_readlane_b32 s73, v51, 16
    v_readlane_b32 s74, v51, 32
    v_readlane_b32 s75, v51, 48
    s_max_u32 s72, s72, s73
    s_max_u32 s74, s74, s75
    s_max_u32 s72, s72, s74
    s_add_u32 s72, s72, 3
    s_lshr_b32 s72, s72, 2
    s_min_u32 s72, s72, 15
    s_max_u32 s76, s72, 11
    s_lshl_b32 s72, s76, 2
    s_sub_u32 s72, 64, s72
    s_lshr_b32 s73, -1, s72
    s_mov_b32 s77, 0
    s_mov_b32 s75, 85
    s_waitcnt lgkmcnt(0)
inn_26:
    s_mov_b64 exec, s[86:87]
    s_cbranch_execz rend_27
    v_mad_u32_u24 v88, v88, s88, v89
    v_bitop3_b32 v68, v59, v64, v66 bitop3:0x10
    v_bitop3_b32 v69, s73, v65, v67 bitop3:0x10
    v_bfe_u32 v73, v88, 11, 8
    v_cmp_gt_u32 s[80:81], s75, v73
    v_cmp_ne_u32 s[82:83], 0, v69
    v_cmp_eq_u32 vcc, 0, v68
    v_bfe_u32 v73, v88, 19, 5
    s_and_b64 s[80:81], s[80:81], s[82:83]
    s_andn2_b64 s[78:79], vcc, s[82:83]
    s_or_b64 vcc, vcc, s[80:81]
    s_andn2_b64 exec, exec, s[78:79]
    v_cndmask_b32 v72, v68, v69, vcc
    v_cndmask_b32 v74, 0, 32, vcc
    v_alignbit_b32 v72, v72, v72, v73
    v_ffbl_b32 v72, v72
    v_add_u32 v72, v72, v73
    v_and_or_b32 v72, v72, 31, v74
    v_lshlrev_b64 v[70:71], v72, v[52:53]
    ds_or_rtn_b64 v[64:65], v57, v[70:71] offset:50176
    ds_or_rtn_b64 v[66:67], v58, v[70:71] offset:50688
    v_lshl_add_u32 v72, v72, 1, v62
    s_add_u32 s77, s77, 1
    s_waitcnt lgkmcnt(1)
    v_and_b32 v73, v64, v70
    v_and_or_b32 v73, v65, v71, v73
    v_cmp_eq_u32 s[80:81], 0, v73
    s_waitcnt lgkmcnt(0)
    v_and_b32 v73, v66, v70
    v_and_or_b32 v73, v67, v71, v73
    v_cmp_eq_u32 s[82:83], 0, v73
    s_nop 0
    s_and_b64 exec, s[80:81], s[82:83]
    s_andn2_b64 s[86:87], s[86:87], exec
    ds_write_b16 v72, v56 offset:40960
    s_andn2_b64 exec, s[80:81], s[82:83]
    ds_xor_b64 v57, v[70:71] offset:50176
    s_andn2_b64 exec, s[82:83], s[80:81]
    ds_xor_b64 v58, v[70:71] offset:50688
    s_cmp_lt_u32 s77, 3
    s_cbranch_scc1 inn_26
rend_27:
    s_mov_b64 exec, s[86:87]
    ds_add_rtn_u32 v60, v57, v61 offset:51204
    s_mov_b64 exec, -1
    v_mov_b32 v90, v48
    v_mov_b32 v74, -1
    v_mov_b32 v75, -1
    s_waitcnt lgkmcnt(0)
    s_barrier
fl_28:
    s_mov_b64 exec, s[86:87]
    s_cbranch_execz fn_31
    ds_read_b64 v[64:65], v57 offset:50176
    ds_read_b32 v66, v57 offset:51204
    v_lshrrev_b32 v67, 16, v60
    v_cmp_eq_u32 s[78:79], 1, v61
    s_waitcnt lgkmcnt(0)
    v_add_u32 v67, v67, v66
    v_cndmask_b32 v60, v67, v60, s[78:79]
    v_and_b32 v60, 0xffff, v60
    v_bfi_b32 v65, v65, 0, s73
    v_not_b32 v64, v64
    v_bfrev_b32 v68, v65
    v_bfrev_b32 v69, v64
    v_min_u32 v60, 64, v60
fr_29:
    v_cmp_ne_u32 vcc, 0, v60
    s_nop 0
    s_and_b64 exec, exec, vcc
    s_cbranch_execz fd_30
    v_lshl_add_u64 v[70:71], v[68:69], 0, v[74:75]
    v_add_u32 v60, -1, v60
    v_and_b32 v68, v68, v70
    v_and_b32 v69, v69, v71
    s_branch fr_29
fd_30:
    s_mov_b64 exec, s[86:87]
    v_ffbl_b32 v70, v68
    v_ffbl_b32 v71, v69
    v_or_b32 v72, v68, v69
    v_add_u32 v71, 32, v71
    v_min_u32 v70, v70, v71
    v_cmp_eq_u32 vcc, 0, v72
    v_sub_u32 v70, 63, v70
    v_cmp_gt_u32 s[80:81], 12, v70
    v_lshl_add_u32 v72, v70, 1, v62
    s_and_b64 s[80:81], s[80:81], s[78:79]
    s_or_b64 vcc, vcc, s[80:81]
    s_cbranch_vccnz spl_32
spb_33:
    ds_write_b16 v72, v56 offset:40960
fn_31:
    s_mov_b64 exec, -1
    s_cmp_gt_u32 s71, 768
    s_cbranch_scc1 more_34
    v_mul_u32_u24 v50, 9, v2
    s_lshl_b32 s3, s6, 4
    v_add_u32 v50, s3, v50
    v_lshlrev_b32 v51, 4, v48
    s_lshl_b32 s3, s89, 13
    s_add_u32 s60, s4, s3
    s_addc_u32 s61, s5, 0
    s_add_u32 s60, s60, 786432
    s_addc_u32 s61, s61, 0
    s_lshl_b32 s3, s89, 7
    s_add_u32 s3, s3, 36864
    v_mov_b32 v54, s3
    v_mov_b32 v66, s53
    s_waitcnt vmcnt(0) lgkmcnt(0)
    s_barrier
    ds_read_b32 v68, v55 offset:12
    ds_read_b128 v[56:59], v50 offset:40960
    ds_read_b32 v67, v55 offset:4
    s_waitcnt lgkmcnt(2)
    v_readfirstlane_b32 s77, v68
    s_nop 0
    s_max_u32 s76, s76, s77
    s_add_u32 s77, s76, 1
    s_lshr_b32 s77, s77, 1
    s_cmp_ge_u32 s6, s77
    s_waitcnt lgkmcnt(0)
    s_cbranch_scc1 k_a2n
    s_sub_u32 s77, s77, 1
    global_store_dwordx4 v51, v[56:59], s[60:61] sc1
    s_barrier
    s_mov_b64 exec, 1
    v_lshl_or_b32 v67, v67, 8, s76
    s_waitcnt vmcnt(0)
    ds_add_rtn_u32 v68, v2, v52 offset:39944
    s_waitcnt lgkmcnt(0)
    v_cmp_eq_u32 vcc, s77, v68
    s_cbranch_vccz k_a2e
    global_store_dwordx2 v54, v[66:67], s[4:5] sc1
    s_branch k_a2e
k_a2n:
    s_barrier
k_a2e:
    s_mov_b64 exec, -1
    s_branch k_j2
k_join:
    s_waitcnt vmcnt(0) lgkmcnt(0)
    s_barrier
k_j2:
    v_lshlrev_b32 v13, 16, v13
    v_lshlrev_b32 v14, 16, v14
    ds_read_b32 v40, v2 offset:39936
    v_mov_b32 v3, s53
    s_mov_b32 s10, 0
    s_mov_b32 s33, 0
    s_waitcnt lgkmcnt(0)
    v_readfirstlane_b32 s21, v40
    s_cmp_lt_u32 s6, 10
    s_cbranch_scc0 k_svc
    v_mul_u32_u24 v40, 640, v2
    s_lshl_b32 s27, s11, 7
    s_add_u32 s27, s27, 36864
    v_add_u32 v40, s27, v40
    s_lshl_b32 s27, s11, 13
    s_add_u32 s16, s4, s27
    s_addc_u32 s17, s5, 0
    s_add_u32 s16, s16, 790528
    s_addc_u32 s17, s17, 0
    s_add_u32 s28, s16, 655360
    s_addc_u32 s29, s17, 0
    s_cmp_lt_u32 s11, 77
    s_cselect_b32 exec_lo, 3, 1
    s_mov_b32 exec_hi, 0
    s_branch se_37
sp_35:
    s_sleep 2
se_37:
    global_load_dwordx2 v[42:43], v40, s[4:5] sc1
    s_add_u32 s19, s19, 1
    s_cmp_ge_u32 s19, 4194304
    s_cbranch_scc1 so_36
    s_waitcnt vmcnt(0)
    v_cmp_ne_u32 s[34:35], s53, v42
    s_nop 0
    s_and_b64 vcc, s[34:35], 1
    s_cbranch_vccnz sp_35
so_36:
    s_waitcnt vmcnt(0)
    s_mov_b64 exec, -1
    v_readlane_b32 s9, v43, 0
    global_load_dwordx4 v[78:81], v2, s[16:17] offset:-4096 sc1
    global_load_dwordx4 v[82:85], v2, s[16:17] offset:-3072 sc1
    global_load_dwordx4 v[86:89], v2, s[16:17] offset:-2048 sc1
    global_load_dwordx4 v[90:93], v2, s[16:17] offset:-1024 sc1
    global_load_dwordx4 v[94:97], v2, s[16:17] offset:0 sc1
    global_load_dwordx4 v[98:101], v2, s[16:17] offset:1024 sc1
    s_lshr_b32 s32, s9, 8
    s_and_b32 s9, s9, 0xff
    s_cmp_gt_u32 s9, 12
    s_cbranch_scc0 sk_38
    global_load_dwordx4 v[102:105], v2, s[16:17] offset:2048 sc1
sk_38:
    s_cmp_gt_u32 s9, 14
    s_cbranch_scc0 sk_39
    global_load_dwordx2 v[106:107], v2, s[16:17] offset:3072 sc1
sk_39:
    s_cmp_lg_u32 s34, 0
    s_cbranch_scc0 sk_40
    s_mov_b64 exec, 2
    global_load_dwordx2 v[42:43], v40, s[4:5] sc1
    s_mov_b64 exec, -1
sk_40:
    s_waitcnt vmcnt(0)
    v_lshlrev_b32_sdwa v48, 3, v78 dst_sel:DWORD dst_unused:UNUSED_PAD src0_sel:DWORD src1_sel:WORD_0
    v_lshlrev_b32_sdwa v49, 3, v78 dst_sel:DWORD dst_unused:UNUSED_PAD src0_sel:DWORD src1_sel:WORD_1
    v_lshlrev_b32_sdwa v50, 3, v79 dst_sel:DWORD dst_unused:UNUSED_PAD src0_sel:DWORD src1_sel:WORD_0
    v_lshlrev_b32_sdwa v51, 3, v79 dst_sel:DWORD dst_unused:UNUSED_PAD src0_sel:DWORD src1_sel:WORD_1
    v_lshlrev_b32_sdwa v52, 3, v80 dst_sel:DWORD dst_unused:UNUSED_PAD src0_sel:DWORD src1_sel:WORD_0
    v_lshlrev_b32_sdwa v53, 3, v80 dst_sel:DWORD dst_unused:UNUSED_PAD src0_sel:DWORD src1_sel:WORD_1
    v_lshlrev_b32_sdwa v54, 3, v81 dst_sel:DWORD dst_unused:UNUSED_PAD src0_sel:DWORD src1_sel:WORD_0
    v_lshlrev_b32_sdwa v55, 3, v81 dst_sel:DWORD dst_unused:UNUSED_PAD src0_sel:DWORD src1_sel:WORD_1
    v_lshlrev_b32_sdwa v56, 3, v82 dst_sel:DWORD dst_unused:UNUSED_PAD src0_sel:DWORD src1_sel:WORD_0
    v_lshlrev_b32_sdwa v57, 3, v82 dst_sel:DWORD dst_unused:UNUSED_PAD src0_sel:DWORD src1_sel:WORD_1
    v_lshlrev_b32_sdwa v58, 3, v83 dst_sel:DWORD dst_unused:UNUSED_PAD src0_sel:DWORD src1_sel:WORD_0
    v_lshlrev_b32_sdwa v59, 3, v83 dst_sel:DWORD dst_unused:UNUSED_PAD src0_sel:DWORD src1_sel:WORD_1
    v_lshlrev_b32_sdwa v60, 3, v84 dst_sel:DWORD dst_unused:UNUSED_PAD src0_sel:DWORD src1_sel:WORD_0
    v_lshlrev_b32_sdwa v61, 3, v84 dst_sel:DWORD dst_unused:UNUSED_PAD src0_sel:DWORD src1_sel:WORD_1
    v_lshlrev_b32_sdwa v62, 3, v85 dst_sel:DWORD dst_unused:UNUSED_PAD src0_sel:DWORD src1_sel:WORD_0
    v_lshlrev_b32_sdwa v63, 3, v85 dst_sel:DWORD dst_unused:UNUSED_PAD src0_sel:DWORD src1_sel:WORD_1
    v_lshlrev_b32_sdwa v64, 3, v86 dst_sel:DWORD dst_unused:UNUSED_PAD src0_sel:DWORD src1_sel:WORD_0
    v_lshlrev_b32_sdwa v65, 3, v86 dst_sel:DWORD dst_unused:UNUSED_PAD src0_sel:DWORD src1_sel:WORD_1
    v_lshlrev_b32_sdwa v66, 3, v87 dst_sel:DWORD dst_unused:UNUSED_PAD src0_sel:DWORD src1_sel:WORD_0
    v_lshlrev_b32_sdwa v67, 3, v87 dst_sel:DWORD dst_unused:UNUSED_PAD src0_sel:DWORD src1_sel:WORD_1
    v_lshlrev_b32_sdwa v68, 3, v88 dst_sel:DWORD dst_unused:UNUSED_PAD src0_sel:DWORD src1_sel:WORD_0
    v_lshlrev_b32_sdwa v69, 3, v88 dst_sel:DWORD dst_unused:UNUSED_PAD src0_sel:DWORD src1_sel:WORD_1
    v_lshlrev_b32_sdwa v70, 3, v89 dst_sel:DWORD dst_unused:UNUSED_PAD src0_sel:DWORD src1_sel:WORD_0
    v_lshlrev_b32_sdwa v71, 3, v89 dst_sel:DWORD dst_unused:UNUSED_PAD src0_sel:DWORD src1_sel:WORD_1
    v_lshlrev_b32_sdwa v72, 3, v90 dst_sel:DWORD dst_unused:UNUSED_PAD src0_sel:DWORD src1_sel:WORD_0
    v_lshlrev_b32_sdwa v73, 3, v90 dst_sel:DWORD dst_unused:UNUSED_PAD src0_sel:DWORD src1_sel:WORD_1
    v_lshlrev_b32_sdwa v74, 3, v91 dst_sel:DWORD dst_unused:UNUSED_PAD src0_sel:DWORD src1_sel:WORD_0
    v_lshlrev_b32_sdwa v75, 3, v91 dst_sel:DWORD dst_unused:UNUSED_PAD src0_sel:DWORD src1_sel:WORD_1
    v_lshlrev_b32_sdwa v76, 3, v92 dst_sel:DWORD dst_unused:UNUSED_PAD src0_sel:DWORD src1_sel:WORD_0
    v_lshlrev_b32_sdwa v77, 3, v92 dst_sel:DWORD dst_unused:UNUSED_PAD src0_sel:DWORD src1_sel:WORD_1
    v_lshlrev_b32_sdwa v78, 3, v93 dst_sel:DWORD dst_unused:UNUSED_PAD src0_sel:DWORD src1_sel:WORD_0
    v_lshlrev_b32_sdwa v79, 3, v93 dst_sel:DWORD dst_unused:UNUSED_PAD src0_sel:DWORD src1_sel:WORD_1
    v_lshlrev_b32_sdwa v80, 3, v94 dst_sel:DWORD dst_unused:UNUSED_PAD src0_sel:DWORD src1_sel:WORD_0
    v_lshlrev_b32_sdwa v81, 3, v94 dst_sel:DWORD dst_unused:UNUSED_PAD src0_sel:DWORD src1_sel:WORD_1
    v_lshlrev_b32_sdwa v82, 3, v95 dst_sel:DWORD dst_unused:UNUSED_PAD src0_sel:DWORD src1_sel:WORD_0
    v_lshlrev_b32_sdwa v83, 3, v95 dst_sel:DWORD dst_unused:UNUSED_PAD src0_sel:DWORD src1_sel:WORD_1
    v_lshlrev_b32_sdwa v84, 3, v96 dst_sel:DWORD dst_unused:UNUSED_PAD src0_sel:DWORD src1_sel:WORD_0
    v_lshlrev_b32_sdwa v85, 3, v96 dst_sel:DWORD dst_unused:UNUSED_PAD src0_sel:DWORD src1_sel:WORD_1
    v_lshlrev_b32_sdwa v86, 3, v97 dst_sel:DWORD dst_unused:UNUSED_PAD src0_sel:DWORD src1_sel:WORD_0
    v_lshlrev_b32_sdwa v87, 3, v97 dst_sel:DWORD dst_unused:UNUSED_PAD src0_sel:DWORD src1_sel:WORD_1
    v_lshlrev_b32_sdwa v88, 3, v98 dst_sel:DWORD dst_unused:UNUSED_PAD src0_sel:DWORD src1_sel:WORD_0
    v_lshlrev_b32_sdwa v89, 3, v98 dst_sel:DWORD dst_unused:UNUSED_PAD src0_sel:DWORD src1_sel:WORD_1
    v_lshlrev_b32_sdwa v90, 3, v99 dst_sel:DWORD dst_unused:UNUSED_PAD src0_sel:DWORD src1_sel:WORD_0
    v_lshlrev_b32_sdwa v91, 3, v99 dst_sel:DWORD dst_unused:UNUSED_PAD src0_sel:DWORD src1_sel:WORD_1
    v_lshlrev_b32_sdwa v92, 3, v100 dst_sel:DWORD dst_unused:UNUSED_PAD src0_sel:DWORD src1_sel:WORD_0
    v_lshlrev_b32_sdwa v93, 3, v100 dst_sel:DWORD dst_unused:UNUSED_PAD src0_sel:DWORD src1_sel:WORD_1
    v_lshlrev_b32_sdwa v94, 3, v101 dst_sel:DWORD dst_unused:UNUSED_PAD src0_sel:DWORD src1_sel:WORD_0
    v_lshlrev_b32_sdwa v95, 3, v101 dst_sel:DWORD dst_unused:UNUSED_PAD src0_sel:DWORD src1_sel:WORD_1
    s_cmp_gt_u32 s9, 12
    s_cbranch_scc0 ue_41
    v_lshlrev_b32_sdwa v96, 3, v102 dst_sel:DWORD dst_unused:UNUSED_PAD src0_sel:DWORD src1_sel:WORD_0
    v_lshlrev_b32_sdwa v97, 3, v102 dst_sel:DWORD dst_unused:UNUSED_PAD src0_sel:DWORD src1_sel:WORD_1
    v_lshlrev_b32_sdwa v98, 3, v103 dst_sel:DWORD dst_unused:UNUSED_PAD src0_sel:DWORD src1_sel:WORD_0
    v_lshlrev_b32_sdwa v99, 3, v103 dst_sel:DWORD dst_unused:UNUSED_PAD src0_sel:DWORD src1_sel:WORD_1
    v_lshlrev_b32_sdwa v100, 3, v104 dst_sel:DWORD dst_unused:UNUSED_PAD src0_sel:DWORD src1_sel:WORD_0
    v_lshlrev_b32_sdwa v101, 3, v104 dst_sel:DWORD dst_unused:UNUSED_PAD src0_sel:DWORD src1_sel:WORD_1
    v_lshlrev_b32_sdwa v102, 3, v105 dst_sel:DWORD dst_unused:UNUSED_PAD src0_sel:DWORD src1_sel:WORD_0
    v_lshlrev_b32_sdwa v103, 3, v105 dst_sel:DWORD dst_unused:UNUSED_PAD src0_sel:DWORD src1_sel:WORD_1
    s_cmp_gt_u32 s9, 14
    s_cbranch_scc0 ue_41
    v_lshlrev_b32_sdwa v104, 3, v106 dst_sel:DWORD dst_unused:UNUSED_PAD src0_sel:DWORD src1_sel:WORD_0
    v_lshlrev_b32_sdwa v105, 3, v106 dst_sel:DWORD dst_unused:UNUSED_PAD src0_sel:DWORD src1_sel:WORD_1
    v_lshlrev_b32_sdwa v106, 3, v107 dst_sel:DWORD dst_unused:UNUSED_PAD src0_sel:DWORD src1_sel:WORD_0
    v_lshlrev_b32_sdwa v107, 3, v107 dst_sel:DWORD dst_unused:UNUSED_PAD src0_sel:DWORD src1_sel:WORD_1
ue_41:
    s_cmp_lt_u32 s11, 77
    s_cbranch_scc0 sk_42
    s_mov_b64 exec, 2
    v_cmp_ne_u32 vcc, s53, v42
    s_cbranch_vccz bk_43
    s_branch se_46
sp_44:
    s_sleep 2
se_46:
    global_load_dwordx2 v[42:43], v40, s[4:5] sc1
    s_add_u32 s19, s19, 1
    s_cmp_ge_u32 s19, 4194304
    s_cbranch_scc1 so_45
    s_waitcnt vmcnt(0)
    v_cmp_ne_u32 vcc, s53, v42
    s_cbranch_vccnz sp_44
so_45:
    s_waitcnt vmcnt(0)
bk_43:
    s_mov_b64 exec, -1
    v_readlane_b32 s10, v43, 1
    global_load_dwordx4 v[138:141], v2, s[28:29] offset:-4096 sc1
    global_load_dwordx4 v[142:145], v2, s[28:29] offset:-3072 sc1
    global_load_dwordx4 v[146:149], v2, s[28:29] offset:-2048 sc1
    global_load_dwordx4 v[150:153], v2, s[28:29] offset:-1024 sc1
    global_load_dwordx4 v[154:157], v2, s[28:29] offset:0 sc1
    global_load_dwordx4 v[158:161], v2, s[28:29] offset:1024 sc1
    s_lshr_b32 s33, s10, 8
    s_and_b32 s10, s10, 0xff
    s_cmp_gt_u32 s10, 12
    s_cbranch_scc0 sk_47
    global_load_dwordx4 v[162:165], v2, s[28:29] offset:2048 sc1
sk_47:
    s_cmp_gt_u32 s10, 14
    s_cbranch_scc0 sk_48
    global_load_dwordx2 v[166:167], v2, s[28:29] offset:3072 sc1
sk_48:
sk_42:
    s_xor_b32 s27, s21, 1
    s_or_b32 s25, s27, s32
    s_or_b32 s26, s27, s33
    ds_read_b64 v[16:17], v48 offset:0
    ds_read_b64 v[18:19], v49 offset:0
    ds_read_b64 v[20:21], v50 offset:0
    ds_read_b64 v[22:23], v51 offset:0
    ds_read_b64 v[24:25], v52 offset:0
    ds_read_b64 v[26:27], v53 offset:0
    ds_read_b64 v[28:29], v54 offset:0
    ds_read_b64 v[30:31], v55 offset:0
    ds_read_b64 v[32:33], v56 offset:0
    ds_read_b64 v[34:35], v57 offset:0
    ds_read_b64 v[36:37], v58 offset:0
    ds_read_b64 v[38:39], v59 offset:0
    s_branch k_l0
k_loop:
    s_mov_b64 exec, s[22:23]
    global_store_dwordx4 v0, v[40:43], s[14:15] sc1
    global_store_dwordx4 v0, v[44:47], s[56:57] sc1
    s_mov_b64 exec, -1
    s_add_u32 s14, s14, 2621440
    s_addc_u32 s15, s15, 0
k_l0:
    s_setprio 2
    v_mov_b32 v4, 0
    v_mov_b32 v5, 0
    v_mov_b32 v6, 0
    v_mov_b32 v7, 0
    v_add_u32 v3, 1, v3
    s_add_u32 s18, s18, 1
    s_xor_b32 s24, s24, 2621440
    s_add_u32 s54, s12, s24
    s_addc_u32 s55, s13, 0
    s_waitcnt lgkmcnt(8)
    v_smfmac_f32_16x16x64_bf16 v[4:7], v[8:11], v[16:23], v12
    ds_read_b64 v[40:41], v60 offset:0
    ds_read_b64 v[42:43], v61 offset:0
    ds_read_b64 v[44:45], v62 offset:0
    ds_read_b64 v[46:47], v63 offset:0
    s_waitcnt lgkmcnt(8)
    v_smfmac_f32_16x16x64_bf16 v[4:7], v[8:11], v[24:31], v12
    ds_read_b64 v[16:17], v64 offset:0
    ds_read_b64 v[18:19], v65 offset:0
    ds_read_b64 v[20:21], v66 offset:0
    ds_read_b64 v[22:23], v67 offset:0
    s_waitcnt lgkmcnt(8)
    v_smfmac_f32_16x16x64_bf16 v[4:7], v[8:11], v[32:39], v12
    ds_read_b64 v[24:25], v68 offset:0
    ds_read_b64 v[26:27], v69 offset:0
    ds_read_b64 v[28:29], v70 offset:0
    ds_read_b64 v[30:31], v71 offset:0
    s_waitcnt lgkmcnt(8)
    v_smfmac_f32_16x16x64_bf16 v[4:7], v[8:11], v[40:47], v12
    ds_read_b64 v[32:33], v72 offset:0
    ds_read_b64 v[34:35], v73 offset:0
    ds_read_b64 v[36:37], v74 offset:0
    ds_read_b64 v[38:39], v75 offset:0
    s_waitcnt lgkmcnt(8)
    v_smfmac_f32_16x16x64_bf16 v[4:7], v[8:11], v[16:23], v12
    ds_read_b64 v[40:41], v76 offset:0
    ds_read_b64 v[42:43], v77 offset:0
    ds_read_b64 v[44:45], v78 offset:0
    ds_read_b64 v[46:47], v79 offset:0
    s_waitcnt lgkmcnt(8)
    v_smfmac_f32_16x16x64_bf16 v[4:7], v[8:11], v[24:31], v12
    ds_read_b64 v[16:17], v80 offset:0
    ds_read_b64 v[18:19], v81 offset:0
    ds_read_b64 v[20:21], v82 offset:0
    ds_read_b64 v[22:23], v83 offset:0
    s_waitcnt lgkmcnt(8)
    v_smfmac_f32_16x16x64_bf16 v[4:7], v[8:11], v[32:39], v12
    ds_read_b64 v[24:25], v84 offset:0
    ds_read_b64 v[26:27], v85 offset:0
    ds_read_b64 v[28:29], v86 offset:0
    ds_read_b64 v[30:31], v87 offset:0
    s_waitcnt lgkmcnt(8)
    v_smfmac_f32_16x16x64_bf16 v[4:7], v[8:11], v[40:47], v12
    ds_read_b64 v[32:33], v88 offset:0
    ds_read_b64 v[34:35], v89 offset:0
    ds_read_b64 v[36:37], v90 offset:0
    ds_read_b64 v[38:39], v91 offset:0
    s_cmp_eq_u32 s9, 11
    s_cbranch_scc1 tl_50
    s_waitcnt lgkmcnt(8)
    v_smfmac_f32_16x16x64_bf16 v[4:7], v[8:11], v[16:23], v12
    ds_read_b64 v[40:41], v92 offset:0
    ds_read_b64 v[42:43], v93 offset:0
    ds_read_b64 v[44:45], v94 offset:0
    ds_read_b64 v[46:47], v95 offset:0
    s_cmp_eq_u32 s9, 12
    s_cbranch_scc1 tl_51
    s_waitcnt lgkmcnt(8)
    v_smfmac_f32_16x16x64_bf16 v[4:7], v[8:11], v[24:31], v12
    ds_read_b64 v[16:17], v96 offset:0
    ds_read_b64 v[18:19], v97 offset:0
    ds_read_b64 v[20:21], v98 offset:0
    ds_read_b64 v[22:23], v99 offset:0
    s_cmp_eq_u32 s9, 13
    s_cbranch_scc1 tl_52
    s_waitcnt lgkmcnt(8)
    v_smfmac_f32_16x16x64_bf16 v[4:7], v[8:11], v[32:39], v12
    ds_read_b64 v[24:25], v100 offset:0
    ds_read_b64 v[26:27], v101 offset:0
    ds_read_b64 v[28:29], v102 offset:0
    ds_read_b64 v[30:31], v103 offset:0
    s_cmp_eq_u32 s9, 14
    s_cbranch_scc1 tl_53
    s_waitcnt lgkmcnt(8)
    v_smfmac_f32_16x16x64_bf16 v[4:7], v[8:11], v[40:47], v12
    ds_read_b64 v[32:33], v104 offset:0
    ds_read_b64 v[34:35], v105 offset:0
    ds_read_b64 v[36:37], v106 offset:0
    ds_read_b64 v[38:39], v107 offset:0
    s_branch tl_50
tl_50:
    s_waitcnt lgkmcnt(8)
    v_smfmac_f32_16x16x64_bf16 v[4:7], v[8:11], v[16:23], v12
    s_waitcnt lgkmcnt(4)
    v_smfmac_f32_16x16x64_bf16 v[4:7], v[8:11], v[24:31], v12
    s_waitcnt lgkmcnt(0)
    v_smfmac_f32_16x16x64_bf16 v[4:7], v[8:11], v[32:39], v12
    s_branch gd_49
tl_51:
    s_waitcnt lgkmcnt(8)
    v_smfmac_f32_16x16x64_bf16 v[4:7], v[8:11], v[24:31], v12
    s_waitcnt lgkmcnt(4)
    v_smfmac_f32_16x16x64_bf16 v[4:7], v[8:11], v[32:39], v12
    s_waitcnt lgkmcnt(0)
    v_smfmac_f32_16x16x64_bf16 v[4:7], v[8:11], v[40:47], v12
    s_branch gd_49
tl_52:
    s_waitcnt lgkmcnt(8)
    v_smfmac_f32_16x16x64_bf16 v[4:7], v[8:11], v[32:39], v12
    s_waitcnt lgkmcnt(4)
    v_smfmac_f32_16x16x64_bf16 v[4:7], v[8:11], v[40:47], v12
    s_waitcnt lgkmcnt(0)
    v_smfmac_f32_16x16x64_bf16 v[4:7], v[8:11], v[16:23], v12
    s_branch gd_49
tl_53:
    s_waitcnt lgkmcnt(8)
    v_smfmac_f32_16x16x64_bf16 v[4:7], v[8:11], v[40:47], v12
    s_waitcnt lgkmcnt(4)
    v_smfmac_f32_16x16x64_bf16 v[4:7], v[8:11], v[16:23], v12
    s_waitcnt lgkmcnt(0)
    v_smfmac_f32_16x16x64_bf16 v[4:7], v[8:11], v[24:31], v12
gd_49:
    s_cmp_lg_u32 s25, 0
    s_cbranch_scc1 sp_54
    s_cmp_eq_u32 s18, 7
    s_nop 4
    v_mul_f32 v16, v4, v13
    v_mul_f32 v17, v5, v13
    v_mul_f32 v18, v6, v13
    v_mul_f32 v19, v7, v13
    s_cbranch_scc1 tok_55
    v_mul_f32 v20, v16, v13
    v_mul_f32 v21, v17, v13
    v_mul_f32 v22, v18, v13
    v_mul_f32 v23, v19, v13
    v_cvt_pk_bf16_f32 v24, v20, v21
    v_cvt_pk_bf16_f32 v25, v22, v23
    global_store_dwordx2 v0, v[24:25], s[54:55]
tok_55:
    v_cvt_pk_bf16_f32 v1, v16, v17
    v_cvt_pk_bf16_f32 v15, v18, v19
    s_cmp_eq_u32 s10, 0
    s_cbranch_scc1 em_56
    s_cmp_eq_u32 s18, 1
    s_cbranch_scc1 k_ub
k_ubr:
    ds_read_b64 v[16:17], v108 offset:0
    ds_read_b64 v[18:19], v109 offset:0
    ds_read_b64 v[20:21], v110 offset:0
    ds_read_b64 v[22:23], v111 offset:0
    ds_read_b64 v[24:25], v112 offset:0
    ds_read_b64 v[26:27], v113 offset:0
    ds_read_b64 v[28:29], v114 offset:0
    ds_read_b64 v[30:31], v115 offset:0
    ds_read_b64 v[32:33], v116 offset:0
    ds_read_b64 v[34:35], v117 offset:0
    ds_read_b64 v[36:37], v118 offset:0
    ds_read_b64 v[38:39], v119 offset:0
    v_mov_b32 v4, 0
    v_mov_b32 v5, 0
    v_mov_b32 v6, 0
    v_mov_b32 v7, 0
    s_add_u32 s54, s54, 40960
    s_addc_u32 s55, s55, 0
    s_cmp_eq_u32 s18, 7
    s_cbranch_scc1 h7_63
    s_mov_b64 exec, 1
    s_cmp_eq_u32 s21, 0
    s_waitcnt vmcnt(0)
    s_cbranch_scc1 fs_65
    global_store_dword v2, v3, s[38:39] offset:0
fd_66:
    s_mov_b64 exec, -1
hb_64:
    s_setprio 1
    s_waitcnt lgkmcnt(8)
    v_smfmac_f32_16x16x64_bf16 v[4:7], v[8:11], v[16:23], v12
    ds_read_b64 v[40:41], v120 offset:0
    ds_read_b64 v[42:43], v121 offset:0
    ds_read_b64 v[44:45], v122 offset:0
    ds_read_b64 v[46:47], v123 offset:0
    s_waitcnt lgkmcnt(8)
    v_smfmac_f32_16x16x64_bf16 v[4:7], v[8:11], v[24:31], v12
    ds_read_b64 v[16:17], v124 offset:0
    ds_read_b64 v[18:19], v125 offset:0
    ds_read_b64 v[20:21], v126 offset:0
    ds_read_b64 v[22:23], v127 offset:0
    s_waitcnt lgkmcnt(8)
    v_smfmac_f32_16x16x64_bf16 v[4:7], v[8:11], v[32:39], v12
    ds_read_b64 v[24:25], v128 offset:0
    ds_read_b64 v[26:27], v129 offset:0
    ds_read_b64 v[28:29], v130 offset:0
    ds_read_b64 v[30:31], v131 offset:0
    s_waitcnt lgkmcnt(8)
    v_smfmac_f32_16x16x64_bf16 v[4:7], v[8:11], v[40:47], v12
    ds_read_b64 v[32:33], v132 offset:0
    ds_read_b64 v[34:35], v133 offset:0
    ds_read_b64 v[36:37], v134 offset:0
    ds_read_b64 v[38:39], v135 offset:0
    s_waitcnt lgkmcnt(8)
    v_smfmac_f32_16x16x64_bf16 v[4:7], v[8:11], v[16:23], v12
    ds_read_b64 v[40:41], v136 offset:0
    ds_read_b64 v[42:43], v137 offset:0
    ds_read_b64 v[44:45], v138 offset:0
    ds_read_b64 v[46:47], v139 offset:0
    s_waitcnt lgkmcnt(8)
    v_smfmac_f32_16x16x64_bf16 v[4:7], v[8:11], v[24:31], v12
    ds_read_b64 v[16:17], v140 offset:0
    ds_read_b64 v[18:19], v141 offset:0
    ds_read_b64 v[20:21], v142 offset:0
    ds_read_b64 v[22:23], v143 offset:0
    s_waitcnt lgkmcnt(8)
    v_smfmac_f32_16x16x64_bf16 v[4:7], v[8:11], v[32:39], v12
    ds_read_b64 v[24:25], v144 offset:0
    ds_read_b64 v[26:27], v145 offset:0
    ds_read_b64 v[28:29], v146 offset:0
    ds_read_b64 v[30:31], v147 offset:0
    s_waitcnt lgkmcnt(8)
    v_smfmac_f32_16x16x64_bf16 v[4:7], v[8:11], v[40:47], v12
    ds_read_b64 v[32:33], v148 offset:0
    ds_read_b64 v[34:35], v149 offset:0
    ds_read_b64 v[36:37], v150 offset:0
    ds_read_b64 v[38:39], v151 offset:0
    s_cmp_eq_u32 s10, 11
    s_cbranch_scc1 tl_59
    s_waitcnt lgkmcnt(8)
    v_smfmac_f32_16x16x64_bf16 v[4:7], v[8:11], v[16:23], v12
    ds_read_b64 v[40:41], v152 offset:0
    ds_read_b64 v[42:43], v153 offset:0
    ds_read_b64 v[44:45], v154 offset:0
    ds_read_b64 v[46:47], v155 offset:0
    s_cmp_eq_u32 s10, 12
    s_cbranch_scc1 tl_60
    s_waitcnt lgkmcnt(8)
    v_smfmac_f32_16x16x64_bf16 v[4:7], v[8:11], v[24:31], v12
    ds_read_b64 v[16:17], v156 offset:0
    ds_read_b64 v[18:19], v157 offset:0
    ds_read_b64 v[20:21], v158 offset:0
    ds_read_b64 v[22:23], v159 offset:0
    s_cmp_eq_u32 s10, 13
    s_cbranch_scc1 tl_61
    s_waitcnt lgkmcnt(8)
    v_smfmac_f32_16x16x64_bf16 v[4:7], v[8:11], v[32:39], v12
    ds_read_b64 v[24:25], v160 offset:0
    ds_read_b64 v[26:27], v161 offset:0
    ds_read_b64 v[28:29], v162 offset:0
    ds_read_b64 v[30:31], v163 offset:0
    s_cmp_eq_u32 s10, 14
    s_cbranch_scc1 tl_62
    s_waitcnt lgkmcnt(8)
    v_smfmac_f32_16x16x64_bf16 v[4:7], v[8:11], v[40:47], v12
    ds_read_b64 v[32:33], v164 offset:0
    ds_read_b64 v[34:35], v165 offset:0
    ds_read_b64 v[36:37], v166 offset:0
    ds_read_b64 v[38:39], v167 offset:0
    s_branch tl_59
tl_59:
    s_waitcnt lgkmcnt(8)
    v_smfmac_f32_16x16x64_bf16 v[4:7], v[8:11], v[16:23], v12
    s_waitcnt lgkmcnt(4)
    v_smfmac_f32_16x16x64_bf16 v[4:7], v[8:11], v[24:31], v12
    s_waitcnt lgkmcnt(0)
    v_smfmac_f32_16x16x64_bf16 v[4:7], v[8:11], v[32:39], v12
    s_branch gd_58
tl_60:
    s_waitcnt lgkmcnt(8)
    v_smfmac_f32_16x16x64_bf16 v[4:7], v[8:11], v[24:31], v12
    s_waitcnt lgkmcnt(4)
    v_smfmac_f32_16x16x64_bf16 v[4:7], v[8:11], v[32:39], v12
    s_waitcnt lgkmcnt(0)
    v_smfmac_f32_16x16x64_bf16 v[4:7], v[8:11], v[40:47], v12
    s_branch gd_58
tl_61:
    s_waitcnt lgkmcnt(8)
    v_smfmac_f32_16x16x64_bf16 v[4:7], v[8:11], v[32:39], v12
    s_waitcnt lgkmcnt(4)
    v_smfmac_f32_16x16x64_bf16 v[4:7], v[8:11], v[40:47], v12
    s_waitcnt lgkmcnt(0)
    v_smfmac_f32_16x16x64_bf16 v[4:7], v[8:11], v[16:23], v12
    s_branch gd_58
tl_62:
    s_waitcnt lgkmcnt(8)
    v_smfmac_f32_16x16x64_bf16 v[4:7], v[8:11], v[40:47], v12
    s_waitcnt lgkmcnt(4)
    v_smfmac_f32_16x16x64_bf16 v[4:7], v[8:11], v[16:23], v12
    s_waitcnt lgkmcnt(0)
    v_smfmac_f32_16x16x64_bf16 v[4:7], v[8:11], v[24:31], v12
gd_58:
eb_57:
    s_cmp_lg_u32 s26, 0
    s_cbranch_scc1 sp_67
    s_cmp_eq_u32 s18, 7
    s_nop 4
    v_mul_f32 v16, v4, v14
    v_mul_f32 v17, v5, v14
    v_mul_f32 v18, v6, v14
    v_mul_f32 v19, v7, v14
    s_cbranch_scc1 tok_68
    v_mul_f32 v20, v16, v14
    v_mul_f32 v21, v17, v14
    v_mul_f32 v22, v18, v14
    v_mul_f32 v23, v19, v14
    v_cvt_pk_bf16_f32 v24, v20, v21
    v_cvt_pk_bf16_f32 v25, v22, v23
    global_store_dwordx2 v0, v[24:25], s[54:55]
tok_68:
    v_cvt_pk_bf16_f32 v44, v16, v17
    v_cvt_pk_bf16_f32 v45, v18, v19
    v_min_u32 v40, -2, v1
    v_min_u32 v41, -2, v15
    v_min_u32 v44, -2, v44
    v_min_u32 v45, -2, v45
    v_mov_b32_dpp v42, v40 quad_perm:[1,1,3,3] row_mask:0xf bank_mask:0xf
    v_mov_b32_dpp v43, v41 quad_perm:[1,1,3,3] row_mask:0xf bank_mask:0xf
    v_mov_b32_dpp v46, v44 quad_perm:[1,1,3,3] row_mask:0xf bank_mask:0xf
    v_mov_b32_dpp v47, v45 quad_perm:[1,1,3,3] row_mask:0xf bank_mask:0xf
    s_add_u32 s56, s14, 40960
    s_addc_u32 s57, s15, 0
    s_cmp_eq_u32 s18, 7
    s_cbranch_scc1 k_fin
    s_lshl_b32 s27, s6, 12
    s_add_u32 s16, s54, s27
    s_addc_u32 s17, s55, 0
    s_add_u32 m0, s27, 40960
    v_lshrrev_b32 v4, 2, v2
    s_lshr_b32 s27, s6, 1
    s_lshl_b32 s27, s27, 5
    v_add_u32 v4, s27, v4
    v_mov_b32 v5, s53
    s_mov_b64 exec, 1
    s_cmp_eq_u32 s21, 0
    s_waitcnt vmcnt(0)
    s_cbranch_scc1 fs_69
    global_store_dword v2, v3, s[38:39] offset:160
fd_70:
    s_mov_b64 exec, -1
    s_mov_b64 exec, 0xff
gp_71:
    global_load_dword v5, v4, s[36:37] offset:160 sc1
    s_add_u32 s19, s19, 1
    s_waitcnt vmcnt(0)
    s_nop 0
    v_sub_u32 v6, v5, v3
    s_cmp_ge_u32 s19, 4194304
    v_cmp_le_u32 vcc, 2, v6
    s_cbranch_scc1 go_72
    s_cbranch_vccnz gp_71
go_72:
    s_mov_b64 exec, -1
    s_cmp_eq_u32 s6, 9
    global_load_lds_dwordx4 v2, s[16:17] sc1
    global_load_lds_dwordx4 v2, s[16:17] offset:1024 sc1
    global_load_lds_dwordx4 v2, s[16:17] offset:2048 sc1
    s_cbranch_scc1 n4_73
    global_load_lds_dwordx4 v2, s[16:17] offset:3072 sc1
n4_73:
    s_lshl_b32 s28, s18, 1
wl_74:
    ds_read_b32 v7, v2 offset:39940
    s_add_u32 s19, s19, 1
    s_waitcnt lgkmcnt(0)
    v_readfirstlane_b32 s27, v7
    s_nop 0
    s_cmp_ge_u32 s27, s28
    s_cbranch_scc1 wk_75
    s_sleep 1
    s_cmp_lt_u32 s19, 4194304
    s_cbranch_scc1 wl_74
wk_75:
    ds_read_b64 v[16:17], v48 offset:40960
    ds_read_b64 v[18:19], v49 offset:40960
    ds_read_b64 v[20:21], v50 offset:40960
    ds_read_b64 v[22:23], v51 offset:40960
    ds_read_b64 v[24:25], v52 offset:40960
    ds_read_b64 v[26:27], v53 offset:40960
    ds_read_b64 v[28:29], v54 offset:40960
    ds_read_b64 v[30:31], v55 offset:40960
    ds_read_b64 v[32:33], v56 offset:40960
    ds_read_b64 v[34:35], v57 offset:40960
    ds_read_b64 v[36:37], v58 offset:40960
    ds_read_b64 v[38:39], v59 offset:40960
    s_waitcnt vmcnt(0)
    s_barrier
    s_mov_b64 exec, s[22:23]
    global_store_dwordx4 v0, v[40:43], s[14:15] sc1
    global_store_dwordx4 v0, v[44:47], s[56:57] sc1
    s_mov_b64 exec, -1
    s_add_u32 s14, s14, 2621440
    s_addc_u32 s15, s15, 0
    s_setprio 2
    v_mov_b32 v4, 0
    v_mov_b32 v5, 0
    v_mov_b32 v6, 0
    v_mov_b32 v7, 0
    v_add_u32 v3, 1, v3
    s_add_u32 s18, s18, 1
    s_xor_b32 s24, s24, 2621440
    s_add_u32 s54, s12, s24
    s_addc_u32 s55, s13, 0
    s_waitcnt lgkmcnt(8)
    v_smfmac_f32_16x16x64_bf16 v[4:7], v[8:11], v[16:23], v12
    ds_read_b64 v[40:41], v60 offset:40960
    ds_read_b64 v[42:43], v61 offset:40960
    ds_read_b64 v[44:45], v62 offset:40960
    ds_read_b64 v[46:47], v63 offset:40960
    s_waitcnt lgkmcnt(8)
    v_smfmac_f32_16x16x64_bf16 v[4:7], v[8:11], v[24:31], v12
    ds_read_b64 v[16:17], v64 offset:40960
    ds_read_b64 v[18:19], v65 offset:40960
    ds_read_b64 v[20:21], v66 offset:40960
    ds_read_b64 v[22:23], v67 offset:40960
    s_waitcnt lgkmcnt(8)
    v_smfmac_f32_16x16x64_bf16 v[4:7], v[8:11], v[32:39], v12
    ds_read_b64 v[24:25], v68 offset:40960
    ds_read_b64 v[26:27], v69 offset:40960
    ds_read_b64 v[28:29], v70 offset:40960
    ds_read_b64 v[30:31], v71 offset:40960
    s_waitcnt lgkmcnt(8)
    v_smfmac_f32_16x16x64_bf16 v[4:7], v[8:11], v[40:47], v12
    ds_read_b64 v[32:33], v72 offset:40960
    ds_read_b64 v[34:35], v73 offset:40960
    ds_read_b64 v[36:37], v74 offset:40960
    ds_read_b64 v[38:39], v75 offset:40960
    s_waitcnt lgkmcnt(8)
    v_smfmac_f32_16x16x64_bf16 v[4:7], v[8:11], v[16:23], v12
    ds_read_b64 v[40:41], v76 offset:40960
    ds_read_b64 v[42:43], v77 offset:40960
    ds_read_b64 v[44:45], v78 offset:40960
    ds_read_b64 v[46:47], v79 offset:40960
    s_waitcnt lgkmcnt(8)
    v_smfmac_f32_16x16x64_bf16 v[4:7], v[8:11], v[24:31], v12
    ds_read_b64 v[16:17], v80 offset:40960
    ds_read_b64 v[18:19], v81 offset:40960
    ds_read_b64 v[20:21], v82 offset:40960
    ds_read_b64 v[22:23], v83 offset:40960
    s_waitcnt lgkmcnt(8)
    v_smfmac_f32_16x16x64_bf16 v[4:7], v[8:11], v[32:39], v12
    ds_read_b64 v[24:25], v84 offset:40960
    ds_read_b64 v[26:27], v85 offset:40960
    ds_read_b64 v[28:29], v86 offset:40960
    ds_read_b64 v[30:31], v87 offset:40960
    s_waitcnt lgkmcnt(8)
    v_smfmac_f32_16x16x64_bf16 v[4:7], v[8:11], v[40:47], v12
    ds_read_b64 v[32:33], v88 offset:40960
    ds_read_b64 v[34:35], v89 offset:40960
    ds_read_b64 v[36:37], v90 offset:40960
    ds_read_b64 v[38:39], v91 offset:40960
    s_cmp_eq_u32 s9, 11
    s_cbranch_scc1 tl_77
    s_waitcnt lgkmcnt(8)
    v_smfmac_f32_16x16x64_bf16 v[4:7], v[8:11], v[16:23], v12
    ds_read_b64 v[40:41], v92 offset:40960
    ds_read_b64 v[42:43], v93 offset:40960
    ds_read_b64 v[44:45], v94 offset:40960
    ds_read_b64 v[46:47], v95 offset:40960
    s_cmp_eq_u32 s9, 12
    s_cbranch_scc1 tl_78
    s_waitcnt lgkmcnt(8)
    v_smfmac_f32_16x16x64_bf16 v[4:7], v[8:11], v[24:31], v12
    ds_read_b64 v[16:17], v96 offset:40960
    ds_read_b64 v[18:19], v97 offset:40960
    ds_read_b64 v[20:21], v98 offset:40960
    ds_read_b64 v[22:23], v99 offset:40960
    s_cmp_eq_u32 s9, 13
    s_cbranch_scc1 tl_79
    s_waitcnt lgkmcnt(8)
    v_smfmac_f32_16x16x64_bf16 v[4:7], v[8:11], v[32:39], v12
    ds_read_b64 v[24:25], v100 offset:40960
    ds_read_b64 v[26:27], v101 offset:40960
    ds_read_b64 v[28:29], v102 offset:40960
    ds_read_b64 v[30:31], v103 offset:40960
    s_cmp_eq_u32 s9, 14
    s_cbranch_scc1 tl_80
    s_waitcnt lgkmcnt(8)
    v_smfmac_f32_16x16x64_bf16 v[4:7], v[8:11], v[40:47], v12
    ds_read_b64 v[32:33], v104 offset:40960
    ds_read_b64 v[34:35], v105 offset:40960
    ds_read_b64 v[36:37], v106 offset:40960
    ds_read_b64 v[38:39], v107 offset:40960
    s_branch tl_77
tl_77:
    s_waitcnt lgkmcnt(8)
    v_smfmac_f32_16x16x64_bf16 v[4:7], v[8:11], v[16:23], v12
    s_waitcnt lgkmcnt(4)
    v_smfmac_f32_16x16x64_bf16 v[4:7], v[8:11], v[24:31], v12
    s_waitcnt lgkmcnt(0)
    v_smfmac_f32_16x16x64_bf16 v[4:7], v[8:11], v[32:39], v12
    s_branch gd_76
tl_78:
    s_waitcnt lgkmcnt(8)
    v_smfmac_f32_16x16x64_bf16 v[4:7], v[8:11], v[24:31], v12
    s_waitcnt lgkmcnt(4)
    v_smfmac_f32_16x16x64_bf16 v[4:7], v[8:11], v[32:39], v12
    s_waitcnt lgkmcnt(0)
    v_smfmac_f32_16x16x64_bf16 v[4:7], v[8:11], v[40:47], v12
    s_branch gd_76
tl_79:
    s_waitcnt lgkmcnt(8)
    v_smfmac_f32_16x16x64_bf16 v[4:7], v[8:11], v[32:39], v12
    s_waitcnt lgkmcnt(4)
    v_smfmac_f32_16x16x64_bf16 v[4:7], v[8:11], v[40:47], v12
    s_waitcnt lgkmcnt(0)
    v_smfmac_f32_16x16x64_bf16 v[4:7], v[8:11], v[16:23], v12
    s_branch gd_76
tl_80:
    s_waitcnt lgkmcnt(8)
    v_smfmac_f32_16x16x64_bf16 v[4:7], v[8:11], v[40:47], v12
    s_waitcnt lgkmcnt(4)
    v_smfmac_f32_16x16x64_bf16 v[4:7], v[8:11], v[16:23], v12
    s_waitcnt lgkmcnt(0)
    v_smfmac_f32_16x16x64_bf16 v[4:7], v[8:11], v[24:31], v12
gd_76:
    s_cmp_lg_u32 s25, 0
    s_cbranch_scc1 sp_81
    s_nop 5
    v_mul_f32 v16, v4, v13
    v_mul_f32 v17, v5, v13
    v_mul_f32 v18, v6, v13
    v_mul_f32 v19, v7, v13
    v_mul_f32 v20, v16, v13
    v_mul_f32 v21, v17, v13
    v_mul_f32 v22, v18, v13
    v_mul_f32 v23, v19, v13
    v_cvt_pk_bf16_f32 v24, v20, v21
    v_cvt_pk_bf16_f32 v25, v22, v23
    global_store_dwordx2 v0, v[24:25], s[54:55]
tok_82:
    v_cvt_pk_bf16_f32 v1, v16, v17
    v_cvt_pk_bf16_f32 v15, v18, v19
    s_cmp_eq_u32 s10, 0
    s_cbranch_scc1 em_83
    ds_read_b64 v[16:17], v108 offset:40960
    ds_read_b64 v[18:19], v109 offset:40960
    ds_read_b64 v[20:21], v110 offset:40960
    ds_read_b64 v[22:23], v111 offset:40960
    ds_read_b64 v[24:25], v112 offset:40960
    ds_read_b64 v[26:27], v113 offset:40960
    ds_read_b64 v[28:29], v114 offset:40960
    ds_read_b64 v[30:31], v115 offset:40960
    ds_read_b64 v[32:33], v116 offset:40960
    ds_read_b64 v[34:35], v117 offset:40960
    ds_read_b64 v[36:37], v118 offset:40960
    ds_read_b64 v[38:39], v119 offset:40960
    v_mov_b32 v4, 0
    v_mov_b32 v5, 0
    v_mov_b32 v6, 0
    v_mov_b32 v7, 0
    s_add_u32 s54, s54, 40960
    s_addc_u32 s55, s55, 0
    s_mov_b64 exec, 1
    s_cmp_eq_u32 s21, 0
    s_waitcnt vmcnt(0)
    s_cbranch_scc1 fs_90
    global_store_dword v2, v3, s[38:39] offset:0
fd_91:
    s_mov_b64 exec, -1
    s_setprio 1
    s_waitcnt lgkmcnt(8)
    v_smfmac_f32_16x16x64_bf16 v[4:7], v[8:11], v[16:23], v12
    ds_read_b64 v[40:41], v120 offset:40960
    ds_read_b64 v[42:43], v121 offset:40960
    ds_read_b64 v[44:45], v122 offset:40960
    ds_read_b64 v[46:47], v123 offset:40960
    s_waitcnt lgkmcnt(8)
    v_smfmac_f32_16x16x64_bf16 v[4:7], v[8:11], v[24:31], v12
    ds_read_b64 v[16:17], v124 offset:40960
    ds_read_b64 v[18:19], v125 offset:40960
    ds_read_b64 v[20:21], v126 offset:40960
    ds_read_b64 v[22:23], v127 offset:40960
    s_waitcnt lgkmcnt(8)
    v_smfmac_f32_16x16x64_bf16 v[4:7], v[8:11], v[32:39], v12
    ds_read_b64 v[24:25], v128 offset:40960
    ds_read_b64 v[26:27], v129 offset:40960
    ds_read_b64 v[28:29], v130 offset:40960
    ds_read_b64 v[30:31], v131 offset:40960
    s_waitcnt lgkmcnt(8)
    v_smfmac_f32_16x16x64_bf16 v[4:7], v[8:11], v[40:47], v12
    ds_read_b64 v[32:33], v132 offset:40960
    ds_read_b64 v[34:35], v133 offset:40960
    ds_read_b64 v[36:37], v134 offset:40960
    ds_read_b64 v[38:39], v135 offset:40960
    s_waitcnt lgkmcnt(8)
    v_smfmac_f32_16x16x64_bf16 v[4:7], v[8:11], v[16:23], v12
    ds_read_b64 v[40:41], v136 offset:40960
    ds_read_b64 v[42:43], v137 offset:40960
    ds_read_b64 v[44:45], v138 offset:40960
    ds_read_b64 v[46:47], v139 offset:40960
    s_waitcnt lgkmcnt(8)
    v_smfmac_f32_16x16x64_bf16 v[4:7], v[8:11], v[24:31], v12
    ds_read_b64 v[16:17], v140 offset:40960
    ds_read_b64 v[18:19], v141 offset:40960
    ds_read_b64 v[20:21], v142 offset:40960
    ds_read_b64 v[22:23], v143 offset:40960
    s_waitcnt lgkmcnt(8)
    v_smfmac_f32_16x16x64_bf16 v[4:7], v[8:11], v[32:39], v12
    ds_read_b64 v[24:25], v144 offset:40960
    ds_read_b64 v[26:27], v145 offset:40960
    ds_read_b64 v[28:29], v146 offset:40960
    ds_read_b64 v[30:31], v147 offset:40960
    s_waitcnt lgkmcnt(8)
    v_smfmac_f32_16x16x64_bf16 v[4:7], v[8:11], v[40:47], v12
    ds_read_b64 v[32:33], v148 offset:40960
    ds_read_b64 v[34:35], v149 offset:40960
    ds_read_b64 v[36:37], v150 offset:40960
    ds_read_b64 v[38:39], v151 offset:40960
    s_cmp_eq_u32 s10, 11
    s_cbranch_scc1 tl_86
    s_waitcnt lgkmcnt(8)
    v_smfmac_f32_16x16x64_bf16 v[4:7], v[8:11], v[16:23], v12
    ds_read_b64 v[40:41], v152 offset:40960
    ds_read_b64 v[42:43], v153 offset:40960
    ds_read_b64 v[44:45], v154 offset:40960
    ds_read_b64 v[46:47], v155 offset:40960
    s_cmp_eq_u32 s10, 12
    s_cbranch_scc1 tl_87
    s_waitcnt lgkmcnt(8)
    v_smfmac_f32_16x16x64_bf16 v[4:7], v[8:11], v[24:31], v12
    ds_read_b64 v[16:17], v156 offset:40960
    ds_read_b64 v[18:19], v157 offset:40960
    ds_read_b64 v[20:21], v158 offset:40960
    ds_read_b64 v[22:23], v159 offset:40960
    s_cmp_eq_u32 s10, 13
    s_cbranch_scc1 tl_88
    s_waitcnt lgkmcnt(8)
    v_smfmac_f32_16x16x64_bf16 v[4:7], v[8:11], v[32:39], v12
    ds_read_b64 v[24:25], v160 offset:40960
    ds_read_b64 v[26:27], v161 offset:40960
    ds_read_b64 v[28:29], v162 offset:40960
    ds_read_b64 v[30:31], v163 offset:40960
    s_cmp_eq_u32 s10, 14
    s_cbranch_scc1 tl_89
    s_waitcnt lgkmcnt(8)
    v_smfmac_f32_16x16x64_bf16 v[4:7], v[8:11], v[40:47], v12
    ds_read_b64 v[32:33], v164 offset:40960
    ds_read_b64 v[34:35], v165 offset:40960
    ds_read_b64 v[36:37], v166 offset:40960
    ds_read_b64 v[38:39], v167 offset:40960
    s_branch tl_86
tl_86:
    s_waitcnt lgkmcnt(8)
    v_smfmac_f32_16x16x64_bf16 v[4:7], v[8:11], v[16:23], v12
    s_waitcnt lgkmcnt(4)
    v_smfmac_f32_16x16x64_bf16 v[4:7], v[8:11], v[24:31], v12
    s_waitcnt lgkmcnt(0)
    v_smfmac_f32_16x16x64_bf16 v[4:7], v[8:11], v[32:39], v12
    s_branch gd_85
tl_87:
    s_waitcnt lgkmcnt(8)
    v_smfmac_f32_16x16x64_bf16 v[4:7], v[8:11], v[24:31], v12
    s_waitcnt lgkmcnt(4)
    v_smfmac_f32_16x16x64_bf16 v[4:7], v[8:11], v[32:39], v12
    s_waitcnt lgkmcnt(0)
    v_smfmac_f32_16x16x64_bf16 v[4:7], v[8:11], v[40:47], v12
    s_branch gd_85
tl_88:
    s_waitcnt lgkmcnt(8)
    v_smfmac_f32_16x16x64_bf16 v[4:7], v[8:11], v[32:39], v12
    s_waitcnt lgkmcnt(4)
    v_smfmac_f32_16x16x64_bf16 v[4:7], v[8:11], v[40:47], v12
    s_waitcnt lgkmcnt(0)
    v_smfmac_f32_16x16x64_bf16 v[4:7], v[8:11], v[16:23], v12
    s_branch gd_85
tl_89:
    s_waitcnt lgkmcnt(8)
    v_smfmac_f32_16x16x64_bf16 v[4:7], v[8:11], v[40:47], v12
    s_waitcnt lgkmcnt(4)
    v_smfmac_f32_16x16x64_bf16 v[4:7], v[8:11], v[16:23], v12
    s_waitcnt lgkmcnt(0)
    v_smfmac_f32_16x16x64_bf16 v[4:7], v[8:11], v[24:31], v12
gd_85:
eb_84:
    s_cmp_lg_u32 s26, 0
    s_cbranch_scc1 sp_92
    s_nop 5
    v_mul_f32 v16, v4, v14
    v_mul_f32 v17, v5, v14
    v_mul_f32 v18, v6, v14
    v_mul_f32 v19, v7, v14
    v_mul_f32 v20, v16, v14
    v_mul_f32 v21, v17, v14
    v_mul_f32 v22, v18, v14
    v_mul_f32 v23, v19, v14
    v_cvt_pk_bf16_f32 v24, v20, v21
    v_cvt_pk_bf16_f32 v25, v22, v23
    global_store_dwordx2 v0, v[24:25], s[54:55]
tok_93:
    v_cvt_pk_bf16_f32 v44, v16, v17
    v_cvt_pk_bf16_f32 v45, v18, v19
    v_min_u32 v40, -2, v1
    v_min_u32 v41, -2, v15
    v_min_u32 v44, -2, v44
    v_min_u32 v45, -2, v45
    v_mov_b32_dpp v42, v40 quad_perm:[1,1,3,3] row_mask:0xf bank_mask:0xf
    v_mov_b32_dpp v43, v41 quad_perm:[1,1,3,3] row_mask:0xf bank_mask:0xf
    v_mov_b32_dpp v46, v44 quad_perm:[1,1,3,3] row_mask:0xf bank_mask:0xf
    v_mov_b32_dpp v47, v45 quad_perm:[1,1,3,3] row_mask:0xf bank_mask:0xf
    s_add_u32 s56, s14, 40960
    s_addc_u32 s57, s15, 0
    s_lshl_b32 s27, s6, 12
    s_add_u32 s16, s54, s27
    s_addc_u32 s17, s55, 0
    s_add_u32 m0, s27, 0
    v_lshrrev_b32 v4, 2, v2
    s_lshr_b32 s27, s6, 1
    s_lshl_b32 s27, s27, 5
    v_add_u32 v4, s27, v4
    v_mov_b32 v5, s53
    s_mov_b64 exec, 1
    s_cmp_eq_u32 s21, 0
    s_waitcnt vmcnt(0)
    s_cbranch_scc1 fs_94
    global_store_dword v2, v3, s[38:39] offset:160
fd_95:
    s_mov_b64 exec, -1
    s_mov_b64 exec, 0xff
gp_96:
    global_load_dword v5, v4, s[36:37] offset:160 sc1
    s_add_u32 s19, s19, 1
    s_waitcnt vmcnt(0)
    s_nop 0
    v_sub_u32 v6, v5, v3
    s_cmp_ge_u32 s19, 4194304
    v_cmp_le_u32 vcc, 2, v6
    s_cbranch_scc1 go_97
    s_cbranch_vccnz gp_96
go_97:
    s_mov_b64 exec, -1
    s_cmp_eq_u32 s6, 9
    global_load_lds_dwordx4 v2, s[16:17] sc1
    global_load_lds_dwordx4 v2, s[16:17] offset:1024 sc1
    global_load_lds_dwordx4 v2, s[16:17] offset:2048 sc1
    s_cbranch_scc1 n4_98
    global_load_lds_dwordx4 v2, s[16:17] offset:3072 sc1
n4_98:
    s_lshl_b32 s28, s18, 1
wl_99:
    ds_read_b32 v7, v2 offset:39940
    s_add_u32 s19, s19, 1
    s_waitcnt lgkmcnt(0)
    v_readfirstlane_b32 s27, v7
    s_nop 0
    s_cmp_ge_u32 s27, s28
    s_cbranch_scc1 wk_100
    s_sleep 1
    s_cmp_lt_u32 s19, 4194304
    s_cbranch_scc1 wl_99
wk_100:
    ds_read_b64 v[16:17], v48 offset:0
    ds_read_b64 v[18:19], v49 offset:0
    ds_read_b64 v[20:21], v50 offset:0
    ds_read_b64 v[22:23], v51 offset:0
    ds_read_b64 v[24:25], v52 offset:0
    ds_read_b64 v[26:27], v53 offset:0
    ds_read_b64 v[28:29], v54 offset:0
    ds_read_b64 v[30:31], v55 offset:0
    ds_read_b64 v[32:33], v56 offset:0
    ds_read_b64 v[34:35], v57 offset:0
    ds_read_b64 v[36:37], v58 offset:0
    ds_read_b64 v[38:39], v59 offset:0
    s_waitcnt vmcnt(0)
    s_barrier
    s_branch k_loop
k_ub:
    s_waitcnt vmcnt(1)
    v_lshlrev_b32_sdwa v108, 3, v138 dst_sel:DWORD dst_unused:UNUSED_PAD src0_sel:DWORD src1_sel:WORD_0
    v_lshlrev_b32_sdwa v109, 3, v138 dst_sel:DWORD dst_unused:UNUSED_PAD src0_sel:DWORD src1_sel:WORD_1
    v_lshlrev_b32_sdwa v110, 3, v139 dst_sel:DWORD dst_unused:UNUSED_PAD src0_sel:DWORD src1_sel:WORD_0
    v_lshlrev_b32_sdwa v111, 3, v139 dst_sel:DWORD dst_unused:UNUSED_PAD src0_sel:DWORD src1_sel:WORD_1
    v_lshlrev_b32_sdwa v112, 3, v140 dst_sel:DWORD dst_unused:UNUSED_PAD src0_sel:DWORD src1_sel:WORD_0
    v_lshlrev_b32_sdwa v113, 3, v140 dst_sel:DWORD dst_unused:UNUSED_PAD src0_sel:DWORD src1_sel:WORD_1
    v_lshlrev_b32_sdwa v114, 3, v141 dst_sel:DWORD dst_unused:UNUSED_PAD src0_sel:DWORD src1_sel:WORD_0
    v_lshlrev_b32_sdwa v115, 3, v141 dst_sel:DWORD dst_unused:UNUSED_PAD src0_sel:DWORD src1_sel:WORD_1
    v_lshlrev_b32_sdwa v116, 3, v142 dst_sel:DWORD dst_unused:UNUSED_PAD src0_sel:DWORD src1_sel:WORD_0
    v_lshlrev_b32_sdwa v117, 3, v142 dst_sel:DWORD dst_unused:UNUSED_PAD src0_sel:DWORD src1_sel:WORD_1
    v_lshlrev_b32_sdwa v118, 3, v143 dst_sel:DWORD dst_unused:UNUSED_PAD src0_sel:DWORD src1_sel:WORD_0
    v_lshlrev_b32_sdwa v119, 3, v143 dst_sel:DWORD dst_unused:UNUSED_PAD src0_sel:DWORD src1_sel:WORD_1
    v_lshlrev_b32_sdwa v120, 3, v144 dst_sel:DWORD dst_unused:UNUSED_PAD src0_sel:DWORD src1_sel:WORD_0
    v_lshlrev_b32_sdwa v121, 3, v144 dst_sel:DWORD dst_unused:UNUSED_PAD src0_sel:DWORD src1_sel:WORD_1
    v_lshlrev_b32_sdwa v122, 3, v145 dst_sel:DWORD dst_unused:UNUSED_PAD src0_sel:DWORD src1_sel:WORD_0
    v_lshlrev_b32_sdwa v123, 3, v145 dst_sel:DWORD dst_unused:UNUSED_PAD src0_sel:DWORD src1_sel:WORD_1
    v_lshlrev_b32_sdwa v124, 3, v146 dst_sel:DWORD dst_unused:UNUSED_PAD src0_sel:DWORD src1_sel:WORD_0
    v_lshlrev_b32_sdwa v125, 3, v146 dst_sel:DWORD dst_unused:UNUSED_PAD src0_sel:DWORD src1_sel:WORD_1
    v_lshlrev_b32_sdwa v126, 3, v147 dst_sel:DWORD dst_unused:UNUSED_PAD src0_sel:DWORD src1_sel:WORD_0
    v_lshlrev_b32_sdwa v127, 3, v147 dst_sel:DWORD dst_unused:UNUSED_PAD src0_sel:DWORD src1_sel:WORD_1
    v_lshlrev_b32_sdwa v128, 3, v148 dst_sel:DWORD dst_unused:UNUSED_PAD src0_sel:DWORD src1_sel:WORD_0
    v_lshlrev_b32_sdwa v129, 3, v148 dst_sel:DWORD dst_unused:UNUSED_PAD src0_sel:DWORD src1_sel:WORD_1
    v_lshlrev_b32_sdwa v130, 3, v149 dst_sel:DWORD dst_unused:UNUSED_PAD src0_sel:DWORD src1_sel:WORD_0
    v_lshlrev_b32_sdwa v131, 3, v149 dst_sel:DWORD dst_unused:UNUSED_PAD src0_sel:DWORD src1_sel:WORD_1
    v_lshlrev_b32_sdwa v132, 3, v150 dst_sel:DWORD dst_unused:UNUSED_PAD src0_sel:DWORD src1_sel:WORD_0
    v_lshlrev_b32_sdwa v133, 3, v150 dst_sel:DWORD dst_unused:UNUSED_PAD src0_sel:DWORD src1_sel:WORD_1
    v_lshlrev_b32_sdwa v134, 3, v151 dst_sel:DWORD dst_unused:UNUSED_PAD src0_sel:DWORD src1_sel:WORD_0
    v_lshlrev_b32_sdwa v135, 3, v151 dst_sel:DWORD dst_unused:UNUSED_PAD src0_sel:DWORD src1_sel:WORD_1
    v_lshlrev_b32_sdwa v136, 3, v152 dst_sel:DWORD dst_unused:UNUSED_PAD src0_sel:DWORD src1_sel:WORD_0
    v_lshlrev_b32_sdwa v137, 3, v152 dst_sel:DWORD dst_unused:UNUSED_PAD src0_sel:DWORD src1_sel:WORD_1
    v_lshlrev_b32_sdwa v138, 3, v153 dst_sel:DWORD dst_unused:UNUSED_PAD src0_sel:DWORD src1_sel:WORD_0
    v_lshlrev_b32_sdwa v139, 3, v153 dst_sel:DWORD dst_unused:UNUSED_PAD src0_sel:DWORD src1_sel:WORD_1
    v_lshlrev_b32_sdwa v140, 3, v154 dst_sel:DWORD dst_unused:UNUSED_PAD src0_sel:DWORD src1_sel:WORD_0
    v_lshlrev_b32_sdwa v141, 3, v154 dst_sel:DWORD dst_unused:UNUSED_PAD src0_sel:DWORD src1_sel:WORD_1
    v_lshlrev_b32_sdwa v142, 3, v155 dst_sel:DWORD dst_unused:UNUSED_PAD src0_sel:DWORD src1_sel:WORD_0
    v_lshlrev_b32_sdwa v143, 3, v155 dst_sel:DWORD dst_unused:UNUSED_PAD src0_sel:DWORD src1_sel:WORD_1
    v_lshlrev_b32_sdwa v144, 3, v156 dst_sel:DWORD dst_unused:UNUSED_PAD src0_sel:DWORD src1_sel:WORD_0
    v_lshlrev_b32_sdwa v145, 3, v156 dst_sel:DWORD dst_unused:UNUSED_PAD src0_sel:DWORD src1_sel:WORD_1
    v_lshlrev_b32_sdwa v146, 3, v157 dst_sel:DWORD dst_unused:UNUSED_PAD src0_sel:DWORD src1_sel:WORD_0
    v_lshlrev_b32_sdwa v147, 3, v157 dst_sel:DWORD dst_unused:UNUSED_PAD src0_sel:DWORD src1_sel:WORD_1
    v_lshlrev_b32_sdwa v148, 3, v158 dst_sel:DWORD dst_unused:UNUSED_PAD src0_sel:DWORD src1_sel:WORD_0
    v_lshlrev_b32_sdwa v149, 3, v158 dst_sel:DWORD dst_unused:UNUSED_PAD src0_sel:DWORD src1_sel:WORD_1
    v_lshlrev_b32_sdwa v150, 3, v159 dst_sel:DWORD dst_unused:UNUSED_PAD src0_sel:DWORD src1_sel:WORD_0
    v_lshlrev_b32_sdwa v151, 3, v159 dst_sel:DWORD dst_unused:UNUSED_PAD src0_sel:DWORD src1_sel:WORD_1
    v_lshlrev_b32_sdwa v152, 3, v160 dst_sel:DWORD dst_unused:UNUSED_PAD src0_sel:DWORD src1_sel:WORD_0
    v_lshlrev_b32_sdwa v153, 3, v160 dst_sel:DWORD dst_unused:UNUSED_PAD src0_sel:DWORD src1_sel:WORD_1
    v_lshlrev_b32_sdwa v154, 3, v161 dst_sel:DWORD dst_unused:UNUSED_PAD src0_sel:DWORD src1_sel:WORD_0
    v_lshlrev_b32_sdwa v155, 3, v161 dst_sel:DWORD dst_unused:UNUSED_PAD src0_sel:DWORD src1_sel:WORD_1
    s_cmp_gt_u32 s10, 12
    s_cbranch_scc0 ue_101
    v_lshlrev_b32_sdwa v156, 3, v162 dst_sel:DWORD dst_unused:UNUSED_PAD src0_sel:DWORD src1_sel:WORD_0
    v_lshlrev_b32_sdwa v157, 3, v162 dst_sel:DWORD dst_unused:UNUSED_PAD src0_sel:DWORD src1_sel:WORD_1
    v_lshlrev_b32_sdwa v158, 3, v163 dst_sel:DWORD dst_unused:UNUSED_PAD src0_sel:DWORD src1_sel:WORD_0
    v_lshlrev_b32_sdwa v159, 3, v163 dst_sel:DWORD dst_unused:UNUSED_PAD src0_sel:DWORD src1_sel:WORD_1
    v_lshlrev_b32_sdwa v160, 3, v164 dst_sel:DWORD dst_unused:UNUSED_PAD src0_sel:DWORD src1_sel:WORD_0
    v_lshlrev_b32_sdwa v161, 3, v164 dst_sel:DWORD dst_unused:UNUSED_PAD src0_sel:DWORD src1_sel:WORD_1
    v_lshlrev_b32_sdwa v162, 3, v165 dst_sel:DWORD dst_unused:UNUSED_PAD src0_sel:DWORD src1_sel:WORD_0
    v_lshlrev_b32_sdwa v163, 3, v165 dst_sel:DWORD dst_unused:UNUSED_PAD src0_sel:DWORD src1_sel:WORD_1
    s_cmp_gt_u32 s10, 14
    s_cbranch_scc0 ue_101
    v_lshlrev_b32_sdwa v164, 3, v166 dst_sel:DWORD dst_unused:UNUSED_PAD src0_sel:DWORD src1_sel:WORD_0
    v_lshlrev_b32_sdwa v165, 3, v166 dst_sel:DWORD dst_unused:UNUSED_PAD src0_sel:DWORD src1_sel:WORD_1
    v_lshlrev_b32_sdwa v166, 3, v167 dst_sel:DWORD dst_unused:UNUSED_PAD src0_sel:DWORD src1_sel:WORD_0
    v_lshlrev_b32_sdwa v167, 3, v167 dst_sel:DWORD dst_unused:UNUSED_PAD src0_sel:DWORD src1_sel:WORD_1
ue_101:
    s_branch k_ubr
k_svc:
    s_setprio 3
    s_load_dwordx2 s[84:85], s[0:1], 0
    s_lshl_b32 s27, s7, 5
    s_add_u32 s27, s27, s8
    s_lshl_b32 s27, s27, 7
    s_add_u32 s27, s27, 393216
    v_add_u32 v26, s27, v2
    v_lshlrev_b32 v27, 3, v2
    s_lshl_b32 s27, s7, 12
    s_add_u32 s27, s27, 393216
    v_add_u32 v27, s27, v27
    v_lshrrev_b32 v28, 1, v2
    v_min_u32 v28, 152, v28
    v_mov_b32 v29, 1
    v_mov_b32 v20, s53
    v_mov_b32 v21, s53
    v_mov_b32 v32, s53
    v_mov_b32 v33, s53
    v_mov_b32 v34, s53
    v_mov_b32 v35, s53
    s_mov_b32 s40, 0
    s_and_b32 s43, s6, 1
    s_lshl_b32 s41, s43, 12
    s_lshl_b32 s42, s43, 7
    v_bfe_u32 v60, v2, 4, 3
    v_lshrrev_b32 v61, 7, v2
    v_lshl_add_u32 v61, v61, 4, s42
    s_waitcnt lgkmcnt(0)
    s_mov_b32 s84, s84
    s_mov_b32 s85, s85
    s_mov_b32 s86, 2560000
    s_mov_b32 s87, 0x20000
    v_add_u32 v62, 0, v60
    s_mul_i32 s27, s8, 40
    v_add_u32 v62, s27, v62
    v_lshrrev_b32 v63, 6, v62
    v_lshl_add_u32 v63, v63, 3, s7
    v_and_b32 v62, 63, v62
    v_lshl_add_u32 v62, v63, 6, v62
    v_lshl_add_u32 v124, v62, 8, v61
    v_add_u32 v62, 8, v60
    s_mul_i32 s27, s8, 40
    v_add_u32 v62, s27, v62
    v_lshrrev_b32 v63, 6, v62
    v_lshl_add_u32 v63, v63, 3, s7
    v_and_b32 v62, 63, v62
    v_lshl_add_u32 v62, v63, 6, v62
    v_lshl_add_u32 v128, v62, 8, v61
    v_add_u32 v62, 16, v60
    s_mul_i32 s27, s8, 40
    v_add_u32 v62, s27, v62
    v_lshrrev_b32 v63, 6, v62
    v_lshl_add_u32 v63, v63, 3, s7
    v_and_b32 v62, 63, v62
    v_lshl_add_u32 v62, v63, 6, v62
    v_lshl_add_u32 v132, v62, 8, v61
    v_add_u32 v62, 24, v60
    s_mul_i32 s27, s8, 40
    v_add_u32 v62, s27, v62
    v_lshrrev_b32 v63, 6, v62
    v_lshl_add_u32 v63, v63, 3, s7
    v_and_b32 v62, 63, v62
    v_lshl_add_u32 v62, v63, 6, v62
    v_lshl_add_u32 v136, v62, 8, v61
    v_add_u32 v62, 32, v60
    s_mul_i32 s27, s8, 40
    v_add_u32 v62, s27, v62
    v_lshrrev_b32 v63, 6, v62
    v_lshl_add_u32 v63, v63, 3, s7
    v_and_b32 v62, 63, v62
    v_lshl_add_u32 v62, v63, 6, v62
    v_lshl_add_u32 v140, v62, 8, v61
    v_lshrrev_b32 v53, 4, v2
    v_add_u32 v53, 0, v53
    v_mul_u32_u24 v48, 3277, v53
    v_lshrrev_b32 v48, 16, v48
    v_mul_u32_u24 v54, 20, v48
    v_sub_u32 v54, v53, v54
    v_lshlrev_b32 v54, 1, v54
    s_mul_i32 s27, s8, 40
    v_add_u32 v54, s27, v54
    v_lshrrev_b32 v55, 6, v54
    v_lshl_add_u32 v55, v55, 3, s7
    v_and_b32 v54, 63, v54
    v_lshl_add_u32 v54, v55, 6, v54
    s_mov_b32 s27, 81920
    v_mul_lo_u32 v48, v48, s27
    v_lshl_add_u32 v48, v54, 3, v48
    v_lshrrev_b32 v53, 4, v2
    v_add_u32 v53, 64, v53
    v_mul_u32_u24 v49, 3277, v53
    v_lshrrev_b32 v49, 16, v49
    v_mul_u32_u24 v54, 20, v49
    v_sub_u32 v54, v53, v54
    v_lshlrev_b32 v54, 1, v54
    s_mul_i32 s27, s8, 40
    v_add_u32 v54, s27, v54
    v_lshrrev_b32 v55, 6, v54
    v_lshl_add_u32 v55, v55, 3, s7
    v_and_b32 v54, 63, v54
    v_lshl_add_u32 v54, v55, 6, v54
    s_mov_b32 s27, 81920
    v_mul_lo_u32 v49, v49, s27
    v_lshl_add_u32 v49, v54, 3, v49
    v_lshrrev_b32 v53, 4, v2
    v_add_u32 v53, 128, v53
    v_mul_u32_u24 v50, 3277, v53
    v_lshrrev_b32 v50, 16, v50
    v_mul_u32_u24 v54, 20, v50
    v_sub_u32 v54, v53, v54
    v_lshlrev_b32 v54, 1, v54
    s_mul_i32 s27, s8, 40
    v_add_u32 v54, s27, v54
    v_lshrrev_b32 v55, 6, v54
    v_lshl_add_u32 v55, v55, 3, s7
    v_and_b32 v54, 63, v54
    v_lshl_add_u32 v54, v55, 6, v54
    s_mov_b32 s27, 81920
    v_mul_lo_u32 v50, v50, s27
    v_lshl_add_u32 v50, v54, 3, v50
    v_lshrrev_b32 v53, 4, v2
    v_add_u32 v53, 192, v53
    v_mul_u32_u24 v51, 3277, v53
    v_lshrrev_b32 v51, 16, v51
    v_mul_u32_u24 v54, 20, v51
    v_sub_u32 v54, v53, v54
    v_lshlrev_b32 v54, 1, v54
    s_mul_i32 s27, s8, 40
    v_add_u32 v54, s27, v54
    v_lshrrev_b32 v55, 6, v54
    v_lshl_add_u32 v55, v55, 3, s7
    v_and_b32 v54, 63, v54
    v_lshl_add_u32 v54, v55, 6, v54
    s_mov_b32 s27, 81920
    v_mul_lo_u32 v51, v51, s27
    v_lshl_add_u32 v51, v54, 3, v51
    v_lshrrev_b32 v53, 4, v2
    v_add_u32 v53, 256, v53
    v_mul_u32_u24 v52, 3277, v53
    v_lshrrev_b32 v52, 16, v52
    v_mul_u32_u24 v54, 20, v52
    v_sub_u32 v54, v53, v54
    v_lshlrev_b32 v54, 1, v54
    s_mul_i32 s27, s8, 40
    v_add_u32 v54, s27, v54
    v_lshrrev_b32 v55, 6, v54
    v_lshl_add_u32 v55, v55, 3, s7
    v_and_b32 v54, 63, v54
    v_lshl_add_u32 v54, v55, 6, v54
    s_mov_b32 s27, 81920
    v_mul_lo_u32 v52, v52, s27
    v_lshl_add_u32 v52, v54, 3, v52
    v_mul_u32_u24 v61, 40, v61
    v_lshl_add_u32 v61, v60, 3, v61
    s_mul_i32 s27, s43, 1310720
    s_add_u32 s50, s4, s27
    s_addc_u32 s51, s5, 0
    s_add_u32 s50, s50, 9961472
    s_addc_u32 s51, s51, 0
    s_mul_i32 s43, s43, 5120
    s_mov_b32 s25, 1
    s_mov_b32 s26, 0
k_svl:
    s_cmp_ge_u32 s18, 3
    s_cbranch_scc0 sk_102
    s_mov_b32 exec_hi, 0
    global_load_dword v30, v27, s[4:5] sc1
    s_mov_b64 exec, -1
sk_102:
    s_xor_b32 s40, s40, 40960
    s_add_u32 s18, s18, 1
    v_add_u32 v26, 32768, v26
    v_add_u32 v27, 32768, v27
    s_nop 0
    s_cmp_eq_u32 s6, 11
    s_cselect_b32 s27, s18, 0
    s_cmp_ge_u32 s27, 3
    s_cbranch_scc0 pa_103
    s_mov_b64 exec, 0xff
    global_store_dwordx4 v26, v[32:35], s[4:5] sc1
    s_mov_b64 exec, -1
    s_waitcnt vmcnt(1)
    s_branch pb_104
pa_103:
    s_waitcnt vmcnt(0)
pb_104:
    v_cmp_ne_u32 vcc, s53, v30
    s_sub_u32 s27, s18, 3
    s_cmp_eq_u32 vcc_lo, 0
    s_cselect_b32 s27, s27, s26
    s_cmp_ge_u32 s18, 4
    s_cselect_b32 s26, s27, s26
    s_cmp_eq_u32 s18, 2
    s_cbranch_scc0 sk_105
    buffer_load_dwordx4 v[124:127], v124, s[84:87], 0 offen
    buffer_load_dwordx4 v[128:131], v128, s[84:87], 0 offen
    buffer_load_dwordx4 v[132:135], v132, s[84:87], 0 offen
    buffer_load_dwordx4 v[136:139], v136, s[84:87], 0 offen
    buffer_load_dwordx4 v[140:143], v140, s[84:87], 0 offen
sk_105:
    s_lshl_b32 s27, s6, 3
    s_add_u32 s27, s27, s18
    s_cmp_eq_u32 s27, 83
    s_cbranch_scc0 sk_106
    v_lshlrev_b32 v40, 3, v2
    v_add_u32 v40, 57344, v40
    s_mov_b64 exec, 3
    s_branch se_109
sp_107:
    s_sleep 1
se_109:
    global_load_dword v41, v40, s[4:5] sc1
    s_add_u32 s19, s19, 1
    s_cmp_ge_u32 s19, 4194304
    s_cbranch_scc1 so_108
    s_waitcnt vmcnt(0)
    v_cmp_ne_u32 vcc, s53, v41
    s_cbranch_vccnz sp_107
so_108:
    s_waitcnt vmcnt(0)
    s_mov_b64 exec, -1
    s_lshr_b32 s27, s2, 3
    s_lshl_b32 s27, s27, 11
    s_add_u32 s27, s27, 196608
    v_lshl_add_u32 v40, v2, 1, s27
    global_load_dword v41, v40, s[4:5] sc1
sk_106:
    s_cmp_eq_u32 s18, 7
    s_cbranch_scc1 k_z7
    s_cmp_gt_u32 s25, s26
    s_cbranch_scc1 k_sh
    s_cmp_eq_u32 s25, 1
    s_cbranch_scc0 h_110
    global_load_dwordx4 v[64:67], v48, s[50:51] sc1
    global_load_dwordx4 v[68:71], v49, s[50:51] sc1
    global_load_dwordx4 v[72:75], v50, s[50:51] sc1
    global_load_dwordx4 v[76:79], v51, s[50:51] sc1
    global_load_dwordx4 v[80:83], v52, s[50:51] sc1
    s_branch k_sg
h_110:
    s_cmp_eq_u32 s25, 2
    s_cbranch_scc0 h_111
    global_load_dwordx4 v[84:87], v48, s[50:51] sc1
    global_load_dwordx4 v[88:91], v49, s[50:51] sc1
    global_load_dwordx4 v[92:95], v50, s[50:51] sc1
    global_load_dwordx4 v[96:99], v51, s[50:51] sc1
    global_load_dwordx4 v[100:103], v52, s[50:51] sc1
    s_branch k_sg
h_111:
    global_load_dwordx4 v[104:107], v48, s[50:51] sc1
    global_load_dwordx4 v[108:111], v49, s[50:51] sc1
    global_load_dwordx4 v[112:115], v50, s[50:51] sc1
    global_load_dwordx4 v[116:119], v51, s[50:51] sc1
    global_load_dwordx4 v[120:123], v52, s[50:51] sc1
k_sg:
    s_add_u32 s25, s25, 1
    s_add_u32 s50, s50, 2621440
    s_addc_u32 s51, s51, 0
k_sh:
    s_xor_b32 s24, s24, 2621440
    s_add_u32 s54, s12, s24
    s_addc_u32 s55, s13, 0
    s_add_u32 s29, s53, s18
    s_mov_b32 s44, 0x11111
    s_sleep 8
k_sp:
    global_load_dwordx2 v[20:21], v28, s[36:37] sc1
    s_add_u32 s19, s19, 1
    s_waitcnt vmcnt(30)
    s_sleep 2
    v_subrev_u32 v24, s29, v20
    v_subrev_u32 v25, s29, v21
    v_or_b32 v24, v24, v25
    v_cmp_gt_u32 vcc, 2, v24
    s_cmp_ge_u32 s19, 4194304
    s_cselect_b32 s46, -1, vcc_lo
    s_lshr_b32 s48, s46, 1
    s_and_b32 s46, s46, s48
    s_lshr_b32 s48, s46, 2
    s_and_b32 s46, s46, s48
    s_and_b32 s46, s46, s44
    s_cbranch_scc0 k_sp
    s_andn2_b32 s44, s44, s46
k_si:
    s_ff1_i32_b32 s27, s46
    s_bitset0_b32 s46, s27
    s_lshl_b32 s27, s27, 11
    s_add_u32 s27, s27, s41
    s_add_u32 s16, s54, s27
    s_addc_u32 s17, s55, 0
    s_add_u32 s27, s27, s40
    s_add_u32 m0, s27, 81920
    s_cmp_lg_u32 s46, 0
    global_load_lds_dwordx4 v2, s[16:17] sc1
    global_load_lds_dwordx4 v2, s[16:17] offset:1024 sc1
    global_load_lds_dwordx4 v2, s[16:17] offset:2048 sc1
    global_load_lds_dwordx4 v2, s[16:17] offset:3072 sc1
    s_cbranch_scc1 k_si
    s_cmp_lg_u32 s44, 0
    s_cbranch_scc1 k_sp
    s_waitcnt vmcnt(0)
    s_mov_b64 exec, 1
    ds_add_u32 v2, v29 offset:39940
    s_mov_b64 exec, -1
    s_barrier
    s_branch k_svl
k_z7:
    s_mov_b32 s45, s25
k_za:
    s_cmp_gt_u32 s25, s26
    s_cbranch_scc1 k_zae
    s_mul_i32 s27, s25, 10256
    s_cmp_ge_u32 s25, 4
    s_cselect_b32 s28, 51216, 0
    s_add_u32 s27, s27, s28
    s_add_u32 s27, s27, s43
    s_add_u32 m0, s27, 40848
    s_nop 0
    global_load_lds_dwordx4 v48, s[50:51] sc1
    s_add_u32 m0, m0, 1024
    s_nop 0
    global_load_lds_dwordx4 v49, s[50:51] sc1
    s_add_u32 m0, m0, 1024
    s_nop 0
    global_load_lds_dwordx4 v50, s[50:51] sc1
    s_add_u32 m0, m0, 1024
    s_nop 0
    global_load_lds_dwordx4 v51, s[50:51] sc1
    s_add_u32 m0, m0, 1024
    s_nop 0
    global_load_lds_dwordx4 v52, s[50:51] sc1
    s_add_u32 s25, s25, 1
    s_add_u32 s50, s50, 2621440
    s_addc_u32 s51, s51, 0
    s_branch k_za
k_zae:
    v_add_u32 v62, s43, v2
    s_cmp_gt_u32 s45, 1
    s_cbranch_scc0 w_113
    v_add_u32 v63, 51104, v62
    ds_write_b128 v63, v[64:67] offset:0
    ds_write_b128 v63, v[68:71] offset:1024
    ds_write_b128 v63, v[72:75] offset:2048
    ds_write_b128 v63, v[76:79] offset:3072
    ds_write_b128 v63, v[80:83] offset:4096
w_113:
    s_cmp_gt_u32 s45, 2
    s_cbranch_scc0 w_114
    v_add_u32 v63, 61360, v62
    ds_write_b128 v63, v[84:87] offset:0
    ds_write_b128 v63, v[88:91] offset:1024
    ds_write_b128 v63, v[92:95] offset:2048
    ds_write_b128 v63, v[96:99] offset:3072
    ds_write_b128 v63, v[100:103] offset:4096
w_114:
    s_cmp_gt_u32 s45, 3
    s_cbranch_scc0 w_115
    v_add_u32 v63, 71616, v62
    ds_write_b128 v63, v[104:107] offset:0
    ds_write_b128 v63, v[108:111] offset:1024
    ds_write_b128 v63, v[112:115] offset:2048
    ds_write_b128 v63, v[116:119] offset:3072
    ds_write_b128 v63, v[120:123] offset:4096
w_115:
    ds_write_b64 v61, v[124:125] offset:40848
    ds_write_b64 v61, v[126:127] offset:41168
    ds_write_b64 v61, v[128:129] offset:40912
    ds_write_b64 v61, v[130:131] offset:41232
    ds_write_b64 v61, v[132:133] offset:40976
    ds_write_b64 v61, v[134:135] offset:41296
    ds_write_b64 v61, v[136:137] offset:41040
    ds_write_b64 v61, v[138:139] offset:41360
    ds_write_b64 v61, v[140:141] offset:41104
    ds_write_b64 v61, v[142:143] offset:41424
    s_load_dwordx4 s[44:47], s[0:1], 64
    v_bfe_u32 v37, v2, 4, 1
    v_lshrrev_b32 v38, 8, v2
    v_lshl_add_u32 v37, v38, 3, v37
    v_lshlrev_b32 v37, 2, v37
    s_waitcnt lgkmcnt(0)
    s_mov_b32 s80, s46
    s_mov_b32 s81, s47
    s_mov_b32 s82, 2560000
    s_mov_b32 s83, 0x20000
    s_mov_b32 s46, 256
    s_mov_b32 s47, 0x20000
    buffer_load_dword v148, v37, s[44:47], 0 offen offset:0
    buffer_load_dword v149, v37, s[44:47], 0 offen offset:8
    buffer_load_dword v150, v37, s[44:47], 0 offen offset:16
    buffer_load_dword v151, v37, s[44:47], 0 offen offset:24
    buffer_load_dword v152, v37, s[44:47], 0 offen offset:128
    buffer_load_dword v153, v37, s[44:47], 0 offen offset:136
    buffer_load_dword v154, v37, s[44:47], 0 offen offset:144
    buffer_load_dword v155, v37, s[44:47], 0 offen offset:152
    s_waitcnt lgkmcnt(0)
    s_mov_b32 s45, s26
    s_mov_b32 exec_hi, 0
    s_branch se_118
sp_116:
    s_sleep 4
se_118:
    global_load_dword v30, v27, s[4:5] sc1
    s_add_u32 s19, s19, 1
    s_cmp_ge_u32 s19, 4194304
    s_cbranch_scc1 so_117
    s_waitcnt vmcnt(0)
    v_cmp_ne_u32 vcc, s53, v30
    s_cbranch_vccnz sp_116
so_117:
    s_waitcnt vmcnt(0)
    s_mov_b64 exec, -1
    s_mov_b32 s26, 5
k_zb:
    s_cmp_gt_u32 s25, s26
    s_cbranch_scc1 k_zbe
    s_mul_i32 s27, s25, 10256
    s_cmp_ge_u32 s25, 4
    s_cselect_b32 s28, 51216, 0
    s_add_u32 s27, s27, s28
    s_add_u32 s27, s27, s43
    s_add_u32 m0, s27, 40848
    s_nop 0
    global_load_lds_dwordx4 v48, s[50:51] sc1
    s_add_u32 m0, m0, 1024
    s_nop 0
    global_load_lds_dwordx4 v49, s[50:51] sc1
    s_add_u32 m0, m0, 1024
    s_nop 0
    global_load_lds_dwordx4 v50, s[50:51] sc1
    s_add_u32 m0, m0, 1024
    s_nop 0
    global_load_lds_dwordx4 v51, s[50:51] sc1
    s_add_u32 m0, m0, 1024
    s_nop 0
    global_load_lds_dwordx4 v52, s[50:51] sc1
    s_add_u32 s25, s25, 1
    s_add_u32 s50, s50, 2621440
    s_addc_u32 s51, s51, 0
    s_branch k_zb
k_zbe:
    s_barrier
    s_branch k_c0
k_fin:
    s_mov_b64 exec, s[22:23]
    global_store_dwordx4 v0, v[40:43], s[14:15] sc1
    global_store_dwordx4 v0, v[44:47], s[56:57] sc1
    s_mov_b64 exec, -1
    s_load_dwordx4 s[44:47], s[0:1], 64
    v_bfe_u32 v37, v2, 4, 1
    v_lshrrev_b32 v38, 8, v2
    v_lshl_add_u32 v37, v38, 3, v37
    v_lshlrev_b32 v37, 2, v37
    s_waitcnt lgkmcnt(0)
    s_mov_b32 s80, s46
    s_mov_b32 s81, s47
    s_mov_b32 s82, 2560000
    s_mov_b32 s83, 0x20000
    s_mov_b32 s46, 256
    s_mov_b32 s47, 0x20000
    buffer_load_dword v148, v37, s[44:47], 0 offen offset:0
    buffer_load_dword v149, v37, s[44:47], 0 offen offset:8
    buffer_load_dword v150, v37, s[44:47], 0 offen offset:16
    buffer_load_dword v151, v37, s[44:47], 0 offen offset:24
    buffer_load_dword v152, v37, s[44:47], 0 offen offset:128
    buffer_load_dword v153, v37, s[44:47], 0 offen offset:136
    buffer_load_dword v154, v37, s[44:47], 0 offen offset:144
    buffer_load_dword v155, v37, s[44:47], 0 offen offset:152
    s_waitcnt vmcnt(10)
    s_barrier
k_c0:
    s_setprio 0
    s_cmp_lt_u32 s6, 8
    s_cbranch_scc0 sk_119
    s_and_b32 s27, s6, 3
    s_lshl_b32 s27, s27, 13
    s_lshr_b32 s28, s6, 2
    s_mul_i32 s28, s28, 81920
    s_add_u32 s27, s27, s28
    v_add_u32 v40, s27, v2
    ds_write_b128 v40, v[48:51] offset:0
    ds_write_b128 v40, v[52:55] offset:1024
    ds_write_b128 v40, v[56:59] offset:2048
    ds_write_b128 v40, v[60:63] offset:3072
    ds_write_b128 v40, v[64:67] offset:4096
    ds_write_b128 v40, v[68:71] offset:5120
    ds_write_b128 v40, v[72:75] offset:6144
    ds_write_b128 v40, v[76:79] offset:7168
sk_119:
    v_mov_b32 v157, v2
    v_lshrrev_b32 v129, 4, v2
    v_lshrrev_b32 v130, 4, v129
    v_and_b32 v131, 15, v129
    s_mul_i32 s42, s8, 40
    s_lshl_b32 s43, s6, 1
    s_add_u32 s42, s42, s43
    s_lshr_b32 s43, s42, 6
    s_lshl_b32 s43, s43, 3
    s_add_u32 s43, s43, s7
    s_lshl_b32 s43, s43, 6
    s_and_b32 s48, s42, 63
    s_add_u32 s50, s43, s48
    s_add_u32 s42, s42, 24
    s_lshr_b32 s43, s42, 6
    s_lshl_b32 s43, s43, 3
    s_add_u32 s43, s43, s7
    s_lshl_b32 s43, s43, 6
    s_and_b32 s48, s42, 63
    s_add_u32 s51, s43, s48
    s_lshl_b32 s48, s6, 4
    s_add_u32 s48, s48, 40848
    v_and_b32 v132, 3, v131
    v_bfe_u32 v133, v131, 2, 1
    v_add_u32 v134, v132, v133
    v_and_b32 v134, 3, v134
    v_mul_u32_u24 v134, 10256, v134
    v_mul_u32_u24 v133, 81984, v133
    v_mul_u32_u24 v135, 640, v130
    v_add3_u32 v134, v134, v133, v135
    v_lshrrev_b32 v133, 3, v131
    v_lshl_add_u32 v134, v133, 3, v134
    v_add_u32 v166, s48, v134
    v_lshrrev_b32 v136, 2, v131
    v_and_b32 v137, 1, v130
    v_add_u32 v134, v136, v137
    v_and_b32 v134, 3, v134
    v_mul_u32_u24 v134, 10256, v134
    v_mul_u32_u24 v137, 81984, v137
    v_mul_u32_u24 v135, 640, v132
    v_add3_u32 v134, v134, v137, v135
    v_lshrrev_b32 v135, 1, v130
    v_lshl_add_u32 v134, v135, 3, v134
    v_add_u32 v162, s48, v134
    s_lshl_b32 s48, s6, 8
    s_add_u32 s48, s48, 32768
    v_lshl_add_u32 v159, v131, 2, s48
    v_lshl_add_u32 v160, v130, 4, s48
    v_cmp_eq_u32 vcc, v136, v130
    v_mov_b32 v134, 0x80000
    s_nop 0
    v_cndmask_b32 v158, v134, v159, vcc
    v_and_b32 v137, 1, v131
    v_lshlrev_b32 v138, 4, v137
    v_mov_b32 v134, 0x3f80
    v_lshlrev_b32 v134, v138, v134
    v_cndmask_b32 v134, 0, v134, vcc
    v_cmp_gt_u32 vcc, 2, v132
    s_nop 1
    v_cndmask_b32 v161, 0, v134, vcc
    v_cndmask_b32 v167, v134, 0, vcc
    v_mov_b32 v134, 0x44444444
    v_mov_b32 v138, 0xeeeeeeee
    v_cmp_eq_u32 vcc, 1, v137
    s_nop 1
    v_cndmask_b32 v156, v134, v138, vcc
    v_lshrrev_b32 v132, 1, v131
    v_lshl_add_u32 v164, v132, 6, v160
    v_xor_b32 v165, 16, v164
    v_mov_b32 v132, s50
    v_mov_b32 v133, s51
    v_cmp_gt_u32 vcc, 2, v131
    s_nop 1
    v_cndmask_b32 v132, v133, v132, vcc
    v_add_u32 v132, v132, v137
    v_lshlrev_b32 v132, 8, v132
    v_lshl_add_u32 v163, v130, 4, v132
    s_waitcnt lgkmcnt(0)
    v_lshrrev_b32 v49, 4, v157
    v_lshrrev_b32 v50, 4, v49
    v_and_b32 v51, 15, v49
    v_and_b32 v52, 3, v51
    v_lshrrev_b32 v53, 3, v51
    v_lshrrev_b32 v54, 1, v50
    v_and_b32 v55, 1, v51
    v_lshrrev_b32 v56, 1, v51
    v_cmp_eq_u32 s[60:61], 1, v52
    v_cmp_eq_u32 s[62:63], 2, v52
    v_cmp_eq_u32 s[64:65], 3, v52
    v_cmp_eq_u32 s[66:67], v54, v53
    v_cmp_eq_u32 vcc, v55, v54
    v_cmp_eq_u32 s[68:69], 0, v56
    v_cmp_eq_u32 s[70:71], 1, v56
    s_mov_b32 s73, 0x3fb8aa3b
    s_mov_b32 s74, 0x3727c5ac
    s_mov_b32 s75, 0x3c000000
    s_mov_b32 s76, 0xb8800000
    s_and_b64 s[68:69], s[68:69], vcc
    s_and_b64 s[70:71], s[70:71], vcc
    s_cmp_lt_u32 s6, 8
    s_cselect_b32 s48, 4, 2
    v_cmp_gt_u32 s[78:79], s48, v51
    s_lshl_b32 s43, s6, 6
    s_lshl_b32 s30, s6, 10
    v_lshrrev_b32 v45, 4, v2
    v_add_u32 v45, s43, v45
    v_mul_u32_u24 v44, 3277, v45
    v_lshrrev_b32 v44, 16, v44
    v_mul_u32_u24 v46, 20, v44
    v_sub_u32 v46, v45, v46
    v_lshlrev_b32 v46, 1, v46
    s_mul_i32 s27, s8, 40
    v_add_u32 v46, s27, v46
    v_lshrrev_b32 v47, 6, v46
    v_lshl_add_u32 v47, v47, 3, s7
    v_and_b32 v46, 63, v46
    v_lshl_add_u32 v46, v47, 6, v46
    s_mov_b32 s27, 81920
    v_mul_lo_u32 v44, v44, s27
    v_lshl_add_u32 v44, v46, 3, v44
    s_waitcnt vmcnt(0)
    v_bfe_u32 v60, v157, 5, 1
    v_cmp_eq_u32 vcc, 0, v60
    v_mov_b32 v64, 0x3f803f80
    v_mov_b32 v65, 0x3f803f80
    v_mov_b32 v66, 0x3f803f80
    v_mov_b32 v67, 0x3f803f80
    v_mov_b32 v68, 0x3f803f80
    v_mov_b32 v69, 0x3f803f80
    v_mov_b32 v70, 0x3f803f80
    v_mov_b32 v71, 0x3f803f80
    v_mov_b32 v60, 0
    v_mov_b32 v61, 0
    v_mov_b32 v62, 0
    v_mov_b32 v63, 0
    v_cndmask_b32 v148, v148, v64, vcc
    v_cndmask_b32 v149, v149, v64, vcc
    v_cndmask_b32 v150, v150, v64, vcc
    v_cndmask_b32 v151, v151, v64, vcc
    v_cndmask_b32 v152, v152, v64, vcc
    v_cndmask_b32 v153, v153, v64, vcc
    v_cndmask_b32 v154, v154, v64, vcc
    v_cndmask_b32 v155, v155, v64, vcc
    v_smfmac_f32_16x16x64_bf16 v[60:63], v[148:151], v[64:71], v156
    s_nop 0
    v_smfmac_f32_16x16x64_bf16 v[60:63], v[152:155], v[64:71], v156
    s_nop 7
    v_add_f32 v60, v62, v63
    v_mul_f32 v60, 0xbc000000, v60
    s_nop 0
    v_readfirstlane_b32 s72, v60
    s_cmp_lt_u32 s6, 10
    s_cbranch_scc0 sk_120
    s_add_u32 s16, s4, 25690112
    s_addc_u32 s17, s5, 0
    s_add_u32 s40, s4, 23068672
    s_addc_u32 s41, s5, 0
    s_add_u32 s27, s30, 122832
    v_add_u32 v40, s27, v2
k_f6:
    global_load_dwordx4 v[16:19], v44, s[40:41] sc1
k_f7:
    global_load_dwordx4 v[20:23], v44, s[16:17] sc1
    s_add_u32 s19, s19, 1
    s_waitcnt vmcnt(0)
    v_max3_u32 v24, v16, v17, v18
    v_max3_u32 v25, v20, v21, v22
    v_max_u32 v24, v24, v19
    v_max_u32 v25, v25, v23
    v_cmp_eq_u32 s[42:43], -1, v24
    v_cmp_eq_u32 vcc, -1, v25
    s_cmp_ge_u32 s19, 4194304
    s_cbranch_scc1 k_f8
    s_cmp_lg_u64 s[42:43], 0
    s_cbranch_scc1 k_f6
    s_cbranch_vccz k_f8
    s_sleep 1
    s_branch k_f7
k_f8:
    ds_write_b128 v40, v[20:23]
    ds_write_b128 v40, v[16:19] offset:30768
sk_120:
    s_waitcnt lgkmcnt(0)
k_c1:
    s_cmp_ge_u32 s6, 8
    s_cbranch_scc1 one_121
    v_add_u32 v3, 81920, v157
    v_mov_b32 v96, 0
    v_mov_b32 v97, 0
    v_mov_b32 v98, 0
    v_mov_b32 v99, 0
    v_mov_b32 v138, v161
    v_mov_b32 v139, v167
    v_mov_b32 v100, 0
    v_mov_b32 v101, 0
    v_mov_b32 v102, 0
    v_mov_b32 v103, 0
    v_mov_b32 v142, v161
    v_mov_b32 v143, v167
    s_setprio 2
    s_waitcnt vmcnt(0)
    s_barrier
    ds_read_b64 v[8:9], v166 offset:0
    ds_read_b64 v[10:11], v166 offset:320
    ds_read_b64 v[24:25], v166 offset:192
    ds_read_b64 v[26:27], v166 offset:512
    ds_read_b64 v[12:13], v166 offset:2560
    ds_read_b64 v[14:15], v166 offset:2880
    ds_read_b64 v[28:29], v166 offset:2752
    ds_read_b64 v[30:31], v166 offset:3072
    ds_read_b64 v[16:17], v166 offset:5120
    ds_read_b64 v[18:19], v166 offset:5440
    ds_read_b64 v[32:33], v166 offset:5312
    ds_read_b64 v[34:35], v166 offset:5632
    ds_read_b64 v[20:21], v166 offset:7680
    ds_read_b64 v[22:23], v166 offset:8000
    ds_read_b64 v[36:37], v166 offset:7872
    s_waitcnt lgkmcnt(7)
    ds_read_b64 v[38:39], v166 offset:8192
    ds_read_b128 v[40:43], v157 offset:0
    ds_read_b128 v[44:47], v157 offset:1024
    ds_read_b128 v[48:51], v157 offset:2048
    ds_read_b128 v[52:55], v157 offset:3072
    v_mfma_f32_16x16x32_bf16 v[88:91], v[8:11], v[8:11], 0
    v_mfma_f32_16x16x32_bf16 v[92:95], v[24:27], v[24:27], 0
    v_mfma_f32_16x16x32_bf16 v[88:91], v[12:15], v[12:15], v[88:91]
    v_mfma_f32_16x16x32_bf16 v[92:95], v[28:31], v[28:31], v[92:95]
    s_waitcnt lgkmcnt(10)
    v_mfma_f32_16x16x32_bf16 v[88:91], v[16:19], v[16:19], v[88:91]
    s_waitcnt lgkmcnt(8)
    v_mfma_f32_16x16x32_bf16 v[92:95], v[32:35], v[32:35], v[92:95]
    s_waitcnt lgkmcnt(6)
    v_mfma_f32_16x16x32_bf16 v[88:91], v[20:23], v[20:23], v[88:91]
    s_waitcnt lgkmcnt(4)
    v_mfma_f32_16x16x32_bf16 v[92:95], v[36:39], v[36:39], v[92:95]
    v_smfmac_f32_16x16x64_bf16 v[96:99], v[148:151], v[8:15], v156
    v_smfmac_f32_16x16x64_bf16 v[100:103], v[148:151], v[24:31], v156
    v_smfmac_f32_16x16x64_bf16 v[96:99], v[152:155], v[16:23], v156
    v_smfmac_f32_16x16x64_bf16 v[100:103], v[152:155], v[32:39], v156
    s_waitcnt lgkmcnt(3)
    v_mfma_f32_16x16x32_bf16 v[72:75], v[40:43], v[8:11], 0
    ds_read_b128 v[56:59], v157 offset:4096
    v_mfma_f32_16x16x32_bf16 v[76:79], v[40:43], v[24:27], 0
    ds_read_b128 v[60:63], v157 offset:5120
    s_waitcnt lgkmcnt(4)
    v_mfma_f32_16x16x32_bf16 v[72:75], v[44:47], v[12:15], v[72:75]
    ds_read_b128 v[64:67], v157 offset:6144
    v_mfma_f32_16x16x32_bf16 v[76:79], v[44:47], v[28:31], v[76:79]
    ds_read_b128 v[68:71], v157 offset:7168
    s_waitcnt lgkmcnt(5)
    v_mfma_f32_16x16x32_bf16 v[72:75], v[48:51], v[16:19], v[72:75]
    v_cndmask_b32 v4, v88, v89, s[60:61]
    v_cndmask_b32 v5, v92, v93, s[60:61]
    v_mfma_f32_16x16x32_bf16 v[76:79], v[48:51], v[32:35], v[76:79]
    v_add_f32 v6, v96, v97
    v_add_f32 v7, v100, v101
    s_waitcnt lgkmcnt(4)
    v_mfma_f32_16x16x32_bf16 v[72:75], v[52:55], v[20:23], v[72:75]
    v_cndmask_b32 v4, v4, v90, s[62:63]
    v_cndmask_b32 v5, v5, v94, s[62:63]
    v_mfma_f32_16x16x32_bf16 v[76:79], v[52:55], v[36:39], v[76:79]
    v_mul_f32 v96, v6, v6
    s_waitcnt lgkmcnt(3)
    v_mfma_f32_16x16x32_bf16 v[80:83], v[56:59], v[8:11], 0
    ds_read_b128 v[40:43], v157 offset:8192
    v_mfma_f32_16x16x32_bf16 v[84:87], v[56:59], v[24:27], 0
    ds_read_b128 v[44:47], v157 offset:9216
    s_waitcnt lgkmcnt(4)
    v_mfma_f32_16x16x32_bf16 v[80:83], v[60:63], v[12:15], v[80:83]
    ds_read_b128 v[48:51], v157 offset:10240
    v_mfma_f32_16x16x32_bf16 v[84:87], v[60:63], v[28:31], v[84:87]
    ds_read_b128 v[52:55], v157 offset:11264
    v_cvt_pk_bf16_f32 v104, v72, v73
    v_cvt_pk_bf16_f32 v105, v74, v75
    s_waitcnt lgkmcnt(5)
    v_mfma_f32_16x16x32_bf16 v[80:83], v[64:67], v[16:19], v[80:83]
    v_cvt_pk_bf16_f32 v108, v76, v77
    v_cvt_pk_bf16_f32 v109, v78, v79
    v_mfma_f32_16x16x32_bf16 v[84:87], v[64:67], v[32:35], v[84:87]
    v_mul_f32 v100, v7, v7
    v_cndmask_b32 v4, v4, v91, s[64:65]
    v_cndmask_b32 v5, v5, v95, s[64:65]
    s_waitcnt lgkmcnt(4)
    v_mfma_f32_16x16x32_bf16 v[80:83], v[68:71], v[20:23], v[80:83]
    v_mul_f32 v96, s76, v96
    v_mul_f32 v100, s76, v100
    v_mfma_f32_16x16x32_bf16 v[84:87], v[68:71], v[36:39], v[84:87]
    v_fma_f32 v4, v4, s75, v96
    v_fma_f32 v5, v5, s75, v100
    s_waitcnt lgkmcnt(3)
    v_mfma_f32_16x16x32_bf16 v[72:75], v[40:43], v[8:11], 0
    ds_read_b128 v[56:59], v157 offset:12288
    v_mfma_f32_16x16x32_bf16 v[76:79], v[40:43], v[24:27], 0
    ds_read_b128 v[60:63], v157 offset:13312
    s_waitcnt lgkmcnt(4)
    v_mfma_f32_16x16x32_bf16 v[72:75], v[44:47], v[12:15], v[72:75]
    ds_read_b128 v[64:67], v157 offset:14336
    v_mfma_f32_16x16x32_bf16 v[76:79], v[44:47], v[28:31], v[76:79]
    ds_read_b128 v[68:71], v157 offset:15360
    v_cvt_pk_bf16_f32 v106, v80, v81
    v_cvt_pk_bf16_f32 v107, v82, v83
    s_waitcnt lgkmcnt(5)
    v_mfma_f32_16x16x32_bf16 v[72:75], v[48:51], v[16:19], v[72:75]
    v_cvt_pk_bf16_f32 v110, v84, v85
    v_cvt_pk_bf16_f32 v111, v86, v87
    v_mfma_f32_16x16x32_bf16 v[76:79], v[48:51], v[32:35], v[76:79]
    v_max_f32 v4, 0, v4
    v_max_f32 v5, 0, v5
    v_add_f32 v4, s74, v4
    s_waitcnt lgkmcnt(4)
    v_mfma_f32_16x16x32_bf16 v[72:75], v[52:55], v[20:23], v[72:75]
    v_add_f32 v5, s74, v5
    v_mfma_f32_16x16x32_bf16 v[76:79], v[52:55], v[36:39], v[76:79]
    v_rsq_f32 v4, v4
    v_rsq_f32 v5, v5
    v_mfma_f32_16x16x32_bf16 v[112:115], v[8:11], v[104:107], 0
    v_mfma_f32_16x16x32_bf16 v[116:119], v[24:27], v[108:111], 0
    s_waitcnt lgkmcnt(3)
    v_mfma_f32_16x16x32_bf16 v[80:83], v[56:59], v[8:11], 0
    ds_read_b128 v[40:43], v157 offset:16384
    v_mfma_f32_16x16x32_bf16 v[84:87], v[56:59], v[24:27], 0
    ds_read_b128 v[44:47], v157 offset:17408
    s_waitcnt lgkmcnt(4)
    v_mfma_f32_16x16x32_bf16 v[80:83], v[60:63], v[12:15], v[80:83]
    ds_read_b128 v[48:51], v157 offset:18432
    v_mfma_f32_16x16x32_bf16 v[84:87], v[60:63], v[28:31], v[84:87]
    ds_read_b128 v[52:55], v157 offset:19456
    s_waitcnt lgkmcnt(5)
    v_mfma_f32_16x16x32_bf16 v[80:83], v[64:67], v[16:19], v[80:83]
    v_cvt_pk_bf16_f32 v104, v72, v73
    v_cvt_pk_bf16_f32 v105, v74, v75
    v_mfma_f32_16x16x32_bf16 v[84:87], v[64:67], v[32:35], v[84:87]
    v_cvt_pk_bf16_f32 v108, v76, v77
    v_cvt_pk_bf16_f32 v109, v78, v79
    s_waitcnt lgkmcnt(4)
    v_mfma_f32_16x16x32_bf16 v[80:83], v[68:71], v[20:23], v[80:83]
    ds_write_b32 v158, v4 offset:0
    v_mfma_f32_16x16x32_bf16 v[84:87], v[68:71], v[36:39], v[84:87]
    ds_write_b32 v158, v5 offset:64
    s_waitcnt lgkmcnt(5)
    v_mfma_f32_16x16x32_bf16 v[72:75], v[40:43], v[8:11], 0
    ds_read_b128 v[56:59], v157 offset:20480
    v_mfma_f32_16x16x32_bf16 v[76:79], v[40:43], v[24:27], 0
    ds_read_b128 v[60:63], v157 offset:21504
    s_waitcnt lgkmcnt(6)
    v_mfma_f32_16x16x32_bf16 v[72:75], v[44:47], v[12:15], v[72:75]
    ds_read_b128 v[64:67], v157 offset:22528
    v_mfma_f32_16x16x32_bf16 v[76:79], v[44:47], v[28:31], v[76:79]
    ds_read_b128 v[68:71], v157 offset:23552
    v_cvt_pk_bf16_f32 v106, v80, v81
    v_cvt_pk_bf16_f32 v107, v82, v83
    s_waitcnt lgkmcnt(7)
    v_mfma_f32_16x16x32_bf16 v[72:75], v[48:51], v[16:19], v[72:75]
    v_cvt_pk_bf16_f32 v110, v84, v85
    v_cvt_pk_bf16_f32 v111, v86, v87
    v_mfma_f32_16x16x32_bf16 v[76:79], v[48:51], v[32:35], v[76:79]
    ds_read_b32 v144, v159 offset:0
    s_waitcnt lgkmcnt(7)
    v_mfma_f32_16x16x32_bf16 v[72:75], v[52:55], v[20:23], v[72:75]
    ds_read_b128 v[120:123], v160 offset:0
    v_mfma_f32_16x16x32_bf16 v[76:79], v[52:55], v[36:39], v[76:79]
    ds_read_b32 v145, v159 offset:64
    ds_read_b128 v[124:127], v160 offset:64
    v_mfma_f32_16x16x32_bf16 v[112:115], v[12:15], v[104:107], v[112:115]
    v_mfma_f32_16x16x32_bf16 v[116:119], v[28:31], v[108:111], v[116:119]
    s_waitcnt lgkmcnt(7)
    v_mfma_f32_16x16x32_bf16 v[80:83], v[56:59], v[8:11], 0
    ds_read_b128 v[40:43], v157 offset:24576
    v_mfma_f32_16x16x32_bf16 v[84:87], v[56:59], v[24:27], 0
    ds_read_b128 v[44:47], v157 offset:25600
    s_waitcnt lgkmcnt(8)
    v_mfma_f32_16x16x32_bf16 v[80:83], v[60:63], v[12:15], v[80:83]
    ds_read_b128 v[48:51], v157 offset:26624
    v_mfma_f32_16x16x32_bf16 v[84:87], v[60:63], v[28:31], v[84:87]
    ds_read_b128 v[52:55], v157 offset:27648
    s_waitcnt lgkmcnt(9)
    v_mfma_f32_16x16x32_bf16 v[80:83], v[64:67], v[16:19], v[80:83]
    v_cvt_pk_bf16_f32 v104, v72, v73
    v_cvt_pk_bf16_f32 v105, v74, v75
    v_mfma_f32_16x16x32_bf16 v[84:87], v[64:67], v[32:35], v[84:87]
    v_cvt_pk_bf16_f32 v108, v76, v77
    v_cvt_pk_bf16_f32 v109, v78, v79
    s_waitcnt lgkmcnt(8)
    v_mfma_f32_16x16x32_bf16 v[80:83], v[68:71], v[20:23], v[80:83]
    v_mfma_f32_16x16x32_bf16 v[84:87], v[68:71], v[36:39], v[84:87]
    s_waitcnt lgkmcnt(3)
    v_mfma_f32_16x16x32_bf16 v[72:75], v[40:43], v[8:11], 0
    ds_read_b128 v[56:59], v157 offset:28672
    v_mfma_f32_16x16x32_bf16 v[76:79], v[40:43], v[24:27], 0
    ds_read_b128 v[60:63], v157 offset:29696
    s_waitcnt lgkmcnt(4)
    v_mfma_f32_16x16x32_bf16 v[72:75], v[44:47], v[12:15], v[72:75]
    ds_read_b128 v[64:67], v157 offset:30720
    v_mfma_f32_16x16x32_bf16 v[76:79], v[44:47], v[28:31], v[76:79]
    ds_read_b128 v[68:71], v157 offset:31744
    s_waitcnt lgkmcnt(5)
    v_mfma_f32_16x16x32_bf16 v[72:75], v[48:51], v[16:19], v[72:75]
    v_cvt_pk_bf16_f32 v106, v80, v81
    v_cvt_pk_bf16_f32 v107, v82, v83
    v_mfma_f32_16x16x32_bf16 v[76:79], v[48:51], v[32:35], v[76:79]
    v_cvt_pk_bf16_f32 v110, v84, v85
    v_cvt_pk_bf16_f32 v111, v86, v87
    s_waitcnt lgkmcnt(4)
    v_mfma_f32_16x16x32_bf16 v[72:75], v[52:55], v[20:23], v[72:75]
    v_mfma_f32_16x16x32_bf16 v[76:79], v[52:55], v[36:39], v[76:79]
    v_mfma_f32_16x16x32_bf16 v[112:115], v[16:19], v[104:107], v[112:115]
    v_mfma_f32_16x16x32_bf16 v[116:119], v[32:35], v[108:111], v[116:119]
    s_waitcnt lgkmcnt(3)
    v_mfma_f32_16x16x32_bf16 v[80:83], v[56:59], v[8:11], 0
    ds_read_b128 v[40:43], v3 offset:0
    v_mfma_f32_16x16x32_bf16 v[84:87], v[56:59], v[24:27], 0
    ds_read_b128 v[44:47], v3 offset:1024
    s_waitcnt lgkmcnt(4)
    v_mfma_f32_16x16x32_bf16 v[80:83], v[60:63], v[12:15], v[80:83]
    ds_read_b128 v[48:51], v3 offset:2048
    v_mfma_f32_16x16x32_bf16 v[84:87], v[60:63], v[28:31], v[84:87]
    ds_read_b128 v[52:55], v3 offset:3072
    s_waitcnt lgkmcnt(5)
    v_mfma_f32_16x16x32_bf16 v[80:83], v[64:67], v[16:19], v[80:83]
    v_cvt_pk_bf16_f32 v104, v72, v73
    v_cvt_pk_bf16_f32 v105, v74, v75
    v_mfma_f32_16x16x32_bf16 v[84:87], v[64:67], v[32:35], v[84:87]
    v_cvt_pk_bf16_f32 v108, v76, v77
    v_cvt_pk_bf16_f32 v109, v78, v79
    s_waitcnt lgkmcnt(4)
    v_mfma_f32_16x16x32_bf16 v[80:83], v[68:71], v[20:23], v[80:83]
    v_mfma_f32_16x16x32_bf16 v[84:87], v[68:71], v[36:39], v[84:87]
    s_waitcnt lgkmcnt(3)
    v_mfma_f32_16x16x32_bf16 v[72:75], v[8:11], v[40:43], 0
    ds_read_b128 v[56:59], v3 offset:4096
    v_mfma_f32_16x16x32_bf16 v[76:79], v[24:27], v[40:43], 0
    ds_read_b128 v[60:63], v3 offset:5120
    s_waitcnt lgkmcnt(4)
    v_mfma_f32_16x16x32_bf16 v[72:75], v[12:15], v[44:47], v[72:75]
    ds_read_b128 v[64:67], v3 offset:6144
    v_mfma_f32_16x16x32_bf16 v[76:79], v[28:31], v[44:47], v[76:79]
    ds_read_b128 v[68:71], v3 offset:7168
    s_waitcnt lgkmcnt(5)
    v_mfma_f32_16x16x32_bf16 v[72:75], v[16:19], v[48:51], v[72:75]
    v_cvt_pk_bf16_f32 v106, v80, v81
    v_cvt_pk_bf16_f32 v107, v82, v83
    v_mfma_f32_16x16x32_bf16 v[76:79], v[32:35], v[48:51], v[76:79]
    v_cvt_pk_bf16_f32 v110, v84, v85
    v_cvt_pk_bf16_f32 v111, v86, v87
    s_waitcnt lgkmcnt(4)
    v_mfma_f32_16x16x32_bf16 v[72:75], v[20:23], v[52:55], v[72:75]
    v_mfma_f32_16x16x32_bf16 v[76:79], v[36:39], v[52:55], v[76:79]
    v_mfma_f32_16x16x32_bf16 v[112:115], v[20:23], v[104:107], v[112:115]
    ds_read_b64_tr_b16 v[130:131], v162 offset:0
    v_mfma_f32_16x16x32_bf16 v[116:119], v[36:39], v[108:111], v[116:119]
    ds_read_b64_tr_b16 v[134:135], v162 offset:192
    s_setprio 1
    s_waitcnt lgkmcnt(5)
    v_mfma_f32_16x16x32_bf16 v[80:83], v[8:11], v[56:59], 0
    ds_read_b128 v[40:43], v3 offset:8192
    ds_read_b128 v[44:47], v3 offset:9216
    ds_read_b128 v[48:51], v3 offset:10240
    ds_read_b128 v[52:55], v3 offset:11264
    v_cvt_pk_bf16_f32 v128, v72, v73
    v_cvt_pk_bf16_f32 v129, v74, v75
    v_cvt_pk_bf16_f32 v132, v76, v77
    v_cvt_pk_bf16_f32 v133, v78, v79
    v_mfma_f32_16x16x32_bf16 v[84:87], v[24:27], v[56:59], 0
    v_mul_f32 v112, v112, v120
    v_mul_f32 v116, v116, v124
    v_mul_f32 v113, v113, v121
    v_mul_f32 v117, v117, v125
    v_mul_f32 v114, v114, v122
    v_mul_f32 v118, v118, v126
    v_mul_f32 v115, v115, v123
    v_mul_f32 v119, v119, v127
    v_max3_f32 v4, v112, v113, v114
    v_max3_f32 v6, v116, v117, v118
    v_max_f32 v4, v4, v115
    v_max_f32 v6, v6, v119
    s_waitcnt lgkmcnt(8)
    v_mfma_f32_16x16x32_bf16 v[80:83], v[12:15], v[60:63], v[80:83]
    v_mov_b32 v5, v4
    v_mov_b32 v7, v6
    s_nop 0
    v_permlane16_swap_b32 v5, v4
    v_permlane16_swap_b32 v7, v6
    v_max_f32 v4, v4, v5
    v_max_f32 v6, v6, v7
    v_mul_f32 v4, v4, v144
    v_mul_f32 v6, v6, v145
    v_fma_f32 v112, v112, v144, -v4
    v_fma_f32 v116, v116, v145, -v6
    v_mfma_f32_16x16x32_bf16 v[84:87], v[28:31], v[60:63], v[84:87]
    v_fma_f32 v113, v113, v144, -v4
    v_fma_f32 v117, v117, v145, -v6
    v_fma_f32 v114, v114, v144, -v4
    v_fma_f32 v118, v118, v145, -v6
    v_fma_f32 v115, v115, v144, -v4
    v_fma_f32 v119, v119, v145, -v6
    v_exp_f32 v112, v112
    v_exp_f32 v116, v116
    v_exp_f32 v113, v113
    s_waitcnt lgkmcnt(7)
    v_mfma_f32_16x16x32_bf16 v[80:83], v[16:19], v[64:67], v[80:83]
    v_exp_f32 v117, v117
    v_exp_f32 v114, v114
    v_exp_f32 v118, v118
    v_exp_f32 v115, v115
    v_exp_f32 v119, v119
    v_add_f32 v4, v112, v113
    v_add_f32 v6, v116, v117
    v_add_f32 v5, v114, v115
    v_mfma_f32_16x16x32_bf16 v[84:87], v[32:35], v[64:67], v[84:87]
    v_add_f32 v7, v118, v119
    v_add_f32 v4, v4, v5
    v_add_f32 v6, v6, v7
    v_mov_b32 v5, v4
    v_mov_b32 v7, v6
    v_mul_f32 v112, v112, v120
    v_mul_f32 v116, v116, v124
    v_mul_f32 v113, v113, v121
    v_mul_f32 v117, v117, v125
    v_permlane16_swap_b32 v5, v4
    s_waitcnt lgkmcnt(6)
    v_mfma_f32_16x16x32_bf16 v[80:83], v[20:23], v[68:71], v[80:83]
    v_permlane16_swap_b32 v7, v6
    v_add_f32 v4, v4, v5
    v_add_f32 v6, v6, v7
    v_rcp_f32 v4, v4
    v_rcp_f32 v6, v6
    v_mul_f32 v114, v114, v122
    v_mul_f32 v118, v118, v126
    v_mul_f32 v115, v115, v123
    v_mul_f32 v119, v119, v127
    v_cndmask_b32 v4, 0, v4, s[66:67]
    v_mfma_f32_16x16x32_bf16 v[84:87], v[36:39], v[68:71], v[84:87]
    v_cndmask_b32 v6, 0, v6, s[66:67]
    v_mul_f32 v112, v112, v4
    v_mul_f32 v116, v116, v6
    v_mul_f32 v113, v113, v4
    v_mul_f32 v117, v117, v6
    v_mul_f32 v114, v114, v4
    v_mul_f32 v118, v118, v6
    v_mul_f32 v115, v115, v4
    v_mul_f32 v119, v119, v6
    v_cvt_pk_bf16_f32 v136, v112, v113
    v_cvt_pk_bf16_f32 v140, v116, v117
    v_cvt_pk_bf16_f32 v137, v114, v115
    v_cvt_pk_bf16_f32 v141, v118, v119
    s_waitcnt lgkmcnt(5)
    v_mfma_f32_16x16x32_bf16 v[120:123], v[128:131], v[136:139], 0
    ds_read_b64_tr_b16 v[130:131], v162 offset:320
    s_waitcnt lgkmcnt(5)
    v_mfma_f32_16x16x32_bf16 v[124:127], v[132:135], v[140:143], 0
    ds_read_b64_tr_b16 v[134:135], v162 offset:512
    s_waitcnt lgkmcnt(5)
    v_mfma_f32_16x16x32_bf16 v[72:75], v[8:11], v[40:43], 0
    ds_read_b128 v[56:59], v3 offset:12288
    v_mfma_f32_16x16x32_bf16 v[76:79], v[24:27], v[40:43], 0
    ds_read_b128 v[60:63], v3 offset:13312
    s_waitcnt lgkmcnt(6)
    v_mfma_f32_16x16x32_bf16 v[72:75], v[12:15], v[44:47], v[72:75]
    ds_read_b128 v[64:67], v3 offset:14336
    v_mfma_f32_16x16x32_bf16 v[76:79], v[28:31], v[44:47], v[76:79]
    ds_read_b128 v[68:71], v3 offset:15360
    s_waitcnt lgkmcnt(7)
    v_mfma_f32_16x16x32_bf16 v[72:75], v[16:19], v[48:51], v[72:75]
    v_cvt_pk_bf16_f32 v88, v120, v121
    v_cvt_pk_bf16_f32 v89, v122, v123
    v_mfma_f32_16x16x32_bf16 v[76:79], v[32:35], v[48:51], v[76:79]
    v_cvt_pk_bf16_f32 v104, v124, v125
    v_cvt_pk_bf16_f32 v105, v126, v127
    s_waitcnt lgkmcnt(6)
    v_mfma_f32_16x16x32_bf16 v[72:75], v[20:23], v[52:55], v[72:75]
    v_cvt_pk_bf16_f32 v128, v80, v81
    v_cvt_pk_bf16_f32 v129, v82, v83
    v_mfma_f32_16x16x32_bf16 v[76:79], v[36:39], v[52:55], v[76:79]
    v_cvt_pk_bf16_f32 v132, v84, v85
    v_cvt_pk_bf16_f32 v133, v86, v87
    s_waitcnt lgkmcnt(5)
    v_mfma_f32_16x16x32_bf16 v[120:123], v[128:131], v[136:139], 0
    ds_read_b64_tr_b16 v[130:131], v162 offset:2560
    s_waitcnt lgkmcnt(5)
    v_mfma_f32_16x16x32_bf16 v[124:127], v[132:135], v[140:143], 0
    ds_read_b64_tr_b16 v[134:135], v162 offset:2752
    s_waitcnt lgkmcnt(5)
    v_mfma_f32_16x16x32_bf16 v[80:83], v[8:11], v[56:59], 0
    ds_read_b128 v[40:43], v3 offset:16384
    v_mfma_f32_16x16x32_bf16 v[84:87], v[24:27], v[56:59], 0
    ds_read_b128 v[44:47], v3 offset:17408
    s_waitcnt lgkmcnt(6)
    v_mfma_f32_16x16x32_bf16 v[80:83], v[12:15], v[60:63], v[80:83]
    ds_read_b128 v[48:51], v3 offset:18432
    v_mfma_f32_16x16x32_bf16 v[84:87], v[28:31], v[60:63], v[84:87]
    ds_read_b128 v[52:55], v3 offset:19456
    s_waitcnt lgkmcnt(7)
    v_mfma_f32_16x16x32_bf16 v[80:83], v[16:19], v[64:67], v[80:83]
    v_cvt_pk_bf16_f32 v90, v120, v121
    v_cvt_pk_bf16_f32 v91, v122, v123
    v_mfma_f32_16x16x32_bf16 v[84:87], v[32:35], v[64:67], v[84:87]
    v_cvt_pk_bf16_f32 v106, v124, v125
    v_cvt_pk_bf16_f32 v107, v126, v127
    s_waitcnt lgkmcnt(6)
    v_mfma_f32_16x16x32_bf16 v[80:83], v[20:23], v[68:71], v[80:83]
    v_cvt_pk_bf16_f32 v128, v72, v73
    v_cvt_pk_bf16_f32 v129, v74, v75
    v_mfma_f32_16x16x32_bf16 v[84:87], v[36:39], v[68:71], v[84:87]
    v_cvt_pk_bf16_f32 v132, v76, v77
    v_cvt_pk_bf16_f32 v133, v78, v79
    s_waitcnt lgkmcnt(5)
    v_mfma_f32_16x16x32_bf16 v[120:123], v[128:131], v[136:139], 0
    ds_read_b64_tr_b16 v[130:131], v162 offset:2880
    s_waitcnt lgkmcnt(5)
    v_mfma_f32_16x16x32_bf16 v[124:127], v[132:135], v[140:143], 0
    ds_read_b64_tr_b16 v[134:135], v162 offset:3072
    s_waitcnt lgkmcnt(5)
    v_mfma_f32_16x16x32_bf16 v[72:75], v[8:11], v[40:43], 0
    ds_read_b128 v[56:59], v3 offset:20480
    v_mfma_f32_16x16x32_bf16 v[76:79], v[24:27], v[40:43], 0
    ds_read_b128 v[60:63], v3 offset:21504
    s_waitcnt lgkmcnt(6)
    v_mfma_f32_16x16x32_bf16 v[72:75], v[12:15], v[44:47], v[72:75]
    ds_read_b128 v[64:67], v3 offset:22528
    v_mfma_f32_16x16x32_bf16 v[76:79], v[28:31], v[44:47], v[76:79]
    ds_read_b128 v[68:71], v3 offset:23552
    s_waitcnt lgkmcnt(7)
    v_mfma_f32_16x16x32_bf16 v[72:75], v[16:19], v[48:51], v[72:75]
    v_cvt_pk_bf16_f32 v92, v120, v121
    v_cvt_pk_bf16_f32 v93, v122, v123
    v_mfma_f32_16x16x32_bf16 v[76:79], v[32:35], v[48:51], v[76:79]
    v_cvt_pk_bf16_f32 v108, v124, v125
    v_cvt_pk_bf16_f32 v109, v126, v127
    s_waitcnt lgkmcnt(6)
    v_mfma_f32_16x16x32_bf16 v[72:75], v[20:23], v[52:55], v[72:75]
    v_cvt_pk_bf16_f32 v128, v80, v81
    v_cvt_pk_bf16_f32 v129, v82, v83
    v_mfma_f32_16x16x32_bf16 v[76:79], v[36:39], v[52:55], v[76:79]
    v_cvt_pk_bf16_f32 v132, v84, v85
    v_cvt_pk_bf16_f32 v133, v86, v87
    s_waitcnt lgkmcnt(5)
    v_mfma_f32_16x16x32_bf16 v[120:123], v[128:131], v[136:139], 0
    ds_read_b64_tr_b16 v[130:131], v162 offset:5120
    s_waitcnt lgkmcnt(5)
    v_mfma_f32_16x16x32_bf16 v[124:127], v[132:135], v[140:143], 0
    ds_read_b64_tr_b16 v[134:135], v162 offset:5312
    s_waitcnt lgkmcnt(5)
    v_mfma_f32_16x16x32_bf16 v[80:83], v[8:11], v[56:59], 0
    ds_read_b128 v[40:43], v3 offset:24576
    v_mfma_f32_16x16x32_bf16 v[84:87], v[24:27], v[56:59], 0
    ds_read_b128 v[44:47], v3 offset:25600
    s_waitcnt lgkmcnt(6)
    v_mfma_f32_16x16x32_bf16 v[80:83], v[12:15], v[60:63], v[80:83]
    ds_read_b128 v[48:51], v3 offset:26624
    v_mfma_f32_16x16x32_bf16 v[84:87], v[28:31], v[60:63], v[84:87]
    ds_read_b128 v[52:55], v3 offset:27648
    s_waitcnt lgkmcnt(7)
    v_mfma_f32_16x16x32_bf16 v[80:83], v[16:19], v[64:67], v[80:83]
    v_cvt_pk_bf16_f32 v94, v120, v121
    v_cvt_pk_bf16_f32 v95, v122, v123
    v_mfma_f32_16x16x32_bf16 v[84:87], v[32:35], v[64:67], v[84:87]
    v_cvt_pk_bf16_f32 v110, v124, v125
    v_cvt_pk_bf16_f32 v111, v126, v127
    s_waitcnt lgkmcnt(6)
    v_mfma_f32_16x16x32_bf16 v[80:83], v[20:23], v[68:71], v[80:83]
    v_cvt_pk_bf16_f32 v128, v72, v73
    v_cvt_pk_bf16_f32 v129, v74, v75
    v_mfma_f32_16x16x32_bf16 v[84:87], v[36:39], v[68:71], v[84:87]
    v_cvt_pk_bf16_f32 v132, v76, v77
    v_cvt_pk_bf16_f32 v133, v78, v79
    s_waitcnt lgkmcnt(5)
    v_mfma_f32_16x16x32_bf16 v[120:123], v[128:131], v[136:139], 0
    ds_read_b64_tr_b16 v[130:131], v162 offset:5440
    s_waitcnt lgkmcnt(5)
    v_mfma_f32_16x16x32_bf16 v[124:127], v[132:135], v[140:143], 0
    ds_read_b64_tr_b16 v[134:135], v162 offset:5632
    s_waitcnt lgkmcnt(5)
    v_mfma_f32_16x16x32_bf16 v[72:75], v[8:11], v[40:43], 0
    ds_read_b128 v[56:59], v3 offset:28672
    v_mfma_f32_16x16x32_bf16 v[76:79], v[24:27], v[40:43], 0
    ds_read_b128 v[60:63], v3 offset:29696
    s_waitcnt lgkmcnt(6)
    v_mfma_f32_16x16x32_bf16 v[72:75], v[12:15], v[44:47], v[72:75]
    ds_read_b128 v[64:67], v3 offset:30720
    v_mfma_f32_16x16x32_bf16 v[76:79], v[28:31], v[44:47], v[76:79]
    ds_read_b128 v[68:71], v3 offset:31744
    s_waitcnt lgkmcnt(7)
    v_mfma_f32_16x16x32_bf16 v[72:75], v[16:19], v[48:51], v[72:75]
    v_cvt_pk_bf16_f32 v96, v120, v121
    v_cvt_pk_bf16_f32 v97, v122, v123
    v_mfma_f32_16x16x32_bf16 v[76:79], v[32:35], v[48:51], v[76:79]
    v_cvt_pk_bf16_f32 v112, v124, v125
    v_cvt_pk_bf16_f32 v113, v126, v127
    s_waitcnt lgkmcnt(6)
    v_mfma_f32_16x16x32_bf16 v[72:75], v[20:23], v[52:55], v[72:75]
    v_cvt_pk_bf16_f32 v128, v80, v81
    v_cvt_pk_bf16_f32 v129, v82, v83
    v_mfma_f32_16x16x32_bf16 v[76:79], v[36:39], v[52:55], v[76:79]
    v_cvt_pk_bf16_f32 v132, v84, v85
    v_cvt_pk_bf16_f32 v133, v86, v87
    s_waitcnt lgkmcnt(5)
    v_mfma_f32_16x16x32_bf16 v[120:123], v[128:131], v[136:139], 0
    ds_read_b64_tr_b16 v[130:131], v162 offset:7680
    s_waitcnt lgkmcnt(5)
    v_mfma_f32_16x16x32_bf16 v[124:127], v[132:135], v[140:143], 0
    ds_read_b64_tr_b16 v[134:135], v162 offset:7872
    s_waitcnt lgkmcnt(5)
    v_mfma_f32_16x16x32_bf16 v[80:83], v[8:11], v[56:59], 0
    v_mov_b32 v48, 0
    v_mov_b32 v49, 0
    v_mfma_f32_16x16x32_bf16 v[84:87], v[24:27], v[56:59], 0
    v_mov_b32 v50, 0
    v_mov_b32 v51, 0
    s_waitcnt lgkmcnt(4)
    v_mfma_f32_16x16x32_bf16 v[80:83], v[12:15], v[60:63], v[80:83]
    v_mov_b32 v52, 0
    v_mov_b32 v53, 0
    v_mfma_f32_16x16x32_bf16 v[84:87], v[28:31], v[60:63], v[84:87]
    v_mov_b32 v54, 0
    v_mov_b32 v55, 0
    s_waitcnt lgkmcnt(3)
    v_mfma_f32_16x16x32_bf16 v[80:83], v[16:19], v[64:67], v[80:83]
    v_cvt_pk_bf16_f32 v98, v120, v121
    v_cvt_pk_bf16_f32 v99, v122, v123
    v_mfma_f32_16x16x32_bf16 v[84:87], v[32:35], v[64:67], v[84:87]
    v_cvt_pk_bf16_f32 v114, v124, v125
    v_cvt_pk_bf16_f32 v115, v126, v127
    s_waitcnt lgkmcnt(2)
    v_mfma_f32_16x16x32_bf16 v[80:83], v[20:23], v[68:71], v[80:83]
    v_cvt_pk_bf16_f32 v128, v72, v73
    v_cvt_pk_bf16_f32 v129, v74, v75
    v_mfma_f32_16x16x32_bf16 v[84:87], v[36:39], v[68:71], v[84:87]
    v_cvt_pk_bf16_f32 v132, v76, v77
    v_cvt_pk_bf16_f32 v133, v78, v79
    s_waitcnt lgkmcnt(1)
    v_mfma_f32_16x16x32_bf16 v[120:123], v[128:131], v[136:139], 0
    ds_read_b64_tr_b16 v[130:131], v162 offset:8000
    s_waitcnt lgkmcnt(1)
    v_mfma_f32_16x16x32_bf16 v[124:127], v[132:135], v[140:143], 0
    ds_read_b64_tr_b16 v[134:135], v162 offset:8192
    s_setprio 0
    v_mfma_f32_16x16x32_bf16 v[40:43], v[88:91], v[88:91], 0
    v_mfma_f32_16x16x32_bf16 v[44:47], v[104:107], v[104:107], 0
    v_cvt_pk_bf16_f32 v128, v80, v81
    v_cvt_pk_bf16_f32 v129, v82, v83
    v_mfma_f32_16x16x32_bf16 v[40:43], v[92:95], v[92:95], v[40:43]
    v_cvt_pk_bf16_f32 v132, v84, v85
    v_cvt_pk_bf16_f32 v133, v86, v87
    v_cvt_pk_bf16_f32 v100, v120, v121
    v_mfma_f32_16x16x32_bf16 v[44:47], v[108:111], v[108:111], v[44:47]
    v_cvt_pk_bf16_f32 v101, v122, v123
    v_cvt_pk_bf16_f32 v116, v124, v125
    v_cvt_pk_bf16_f32 v117, v126, v127
    s_waitcnt lgkmcnt(1)
    v_mfma_f32_16x16x32_bf16 v[120:123], v[128:131], v[136:139], 0
    s_waitcnt lgkmcnt(0)
    v_mfma_f32_16x16x32_bf16 v[124:127], v[132:135], v[140:143], 0
    v_mfma_f32_16x16x32_bf16 v[40:43], v[96:99], v[96:99], v[40:43]
    ds_write_b64 v166, v[88:89] offset:0
    ds_write_b64 v166, v[90:91] offset:320
    ds_write_b64 v166, v[104:105] offset:192
    v_mfma_f32_16x16x32_bf16 v[44:47], v[112:115], v[112:115], v[44:47]
    ds_write_b64 v166, v[106:107] offset:512
    ds_write_b64 v166, v[92:93] offset:2560
    ds_write_b64 v166, v[94:95] offset:2880
    v_smfmac_f32_16x16x64_bf16 v[48:51], v[148:151], v[88:95], v156
    ds_write_b64 v166, v[108:109] offset:2752
    ds_write_b64 v166, v[110:111] offset:3072
    ds_write_b64 v166, v[96:97] offset:5120
    v_smfmac_f32_16x16x64_bf16 v[52:55], v[148:151], v[104:111], v156
    ds_write_b64 v166, v[98:99] offset:5440
    ds_write_b64 v166, v[112:113] offset:5312
    ds_write_b64 v166, v[114:115] offset:5632
    v_cvt_pk_bf16_f32 v102, v120, v121
    v_cvt_pk_bf16_f32 v103, v122, v123
    v_cvt_pk_bf16_f32 v118, v124, v125
    v_cvt_pk_bf16_f32 v119, v126, v127
    v_mfma_f32_16x16x32_bf16 v[40:43], v[100:103], v[100:103], v[40:43]
    s_nop 0
    v_mfma_f32_16x16x32_bf16 v[44:47], v[116:119], v[116:119], v[44:47]
    v_smfmac_f32_16x16x64_bf16 v[48:51], v[152:155], v[96:103], v156
    v_smfmac_f32_16x16x64_bf16 v[52:55], v[152:155], v[112:119], v156
    ds_write_b64 v166, v[100:101] offset:7680
    ds_write_b64 v166, v[102:103] offset:8000
    ds_write_b64 v166, v[116:117] offset:7872
    s_waitcnt lgkmcnt(7)
    ds_write_b64 v166, v[118:119] offset:8192
    ds_read_b64_tr_b16 v[8:9], v162 offset:0
    ds_read_b64_tr_b16 v[10:11], v162 offset:192
    ds_read_b64_tr_b16 v[12:13], v162 offset:320
    ds_read_b64_tr_b16 v[14:15], v162 offset:512
    v_cndmask_b32 v4, v40, v41, s[60:61]
    v_cndmask_b32 v6, v44, v45, s[60:61]
    v_add_f32 v5, v48, v49
    v_add_f32 v7, v52, v53
    v_add_f32 v50, v50, v51
    v_add_f32 v54, v54, v55
    v_cndmask_b32 v4, v4, v42, s[62:63]
    v_cndmask_b32 v6, v6, v46, s[62:63]
    v_mul_f32 v48, v5, v5
    v_mul_f32 v52, v7, v7
    v_cndmask_b32 v4, v4, v43, s[64:65]
    v_cndmask_b32 v6, v6, v47, s[64:65]
    v_mul_f32 v48, s76, v48
    v_mul_f32 v52, s76, v52
    v_fma_f32 v4, v4, s75, v48
    v_fma_f32 v6, v6, s75, v52
    v_max_f32 v4, 0, v4
    v_max_f32 v6, 0, v6
    v_add_f32 v4, s74, v4
    v_add_f32 v6, s74, v6
    v_fma_f32 v50, v5, s72, v50
    v_fma_f32 v54, v7, s72, v54
    v_rsq_f32 v4, v4
    v_rsq_f32 v6, v6
    v_mul_f32 v50, s73, v50
    v_mul_f32 v54, s73, v54
    v_mul_f32 v4, v4, v50
    v_mul_f32 v6, v6, v54
    ds_write_b32 v158, v4 offset:0
    ds_write_b32 v158, v6 offset:64
    ds_read_b128 v[120:123], v164
    s_waitcnt lgkmcnt(7)
    ds_read_b128 v[124:127], v165
    ds_read_b64_tr_b16 v[16:17], v162 offset:2560
    ds_read_b64_tr_b16 v[18:19], v162 offset:2752
    ds_read_b64_tr_b16 v[20:21], v162 offset:2880
    ds_read_b64_tr_b16 v[22:23], v162 offset:3072
    ds_read_b64_tr_b16 v[24:25], v162 offset:5120
    ds_read_b64_tr_b16 v[26:27], v162 offset:5312
    ds_read_b64_tr_b16 v[28:29], v162 offset:5440
    s_waitcnt lgkmcnt(7)
    ds_read_b64_tr_b16 v[30:31], v162 offset:5632
    ds_read_b64_tr_b16 v[32:33], v162 offset:7680
    ds_read_b64_tr_b16 v[34:35], v162 offset:7872
    ds_read_b64_tr_b16 v[36:37], v162 offset:8000
    ds_read_b64_tr_b16 v[38:39], v162 offset:8192
    v_max3_f32 v4, v120, v121, v122
    v_max3_f32 v5, v123, v124, v125
    v_max3_f32 v4, v4, v126, v127
    v_max_f32 v4, v4, v5
    v_sub_f32 v120, v120, v4
    v_sub_f32 v121, v121, v4
    v_sub_f32 v122, v122, v4
    v_sub_f32 v123, v123, v4
    v_sub_f32 v124, v124, v4
    v_sub_f32 v125, v125, v4
    v_sub_f32 v126, v126, v4
    v_sub_f32 v127, v127, v4
    v_exp_f32 v120, v120
    v_exp_f32 v121, v121
    v_exp_f32 v122, v122
    v_exp_f32 v123, v123
    v_exp_f32 v124, v124
    v_exp_f32 v125, v125
    v_exp_f32 v126, v126
    v_exp_f32 v127, v127
    v_add_f32 v4, v120, v121
    v_add_f32 v5, v122, v123
    v_add_f32 v6, v124, v125
    v_add_f32 v7, v126, v127
    v_add_f32 v4, v4, v5
    v_add_f32 v6, v6, v7
    v_add_f32 v4, v4, v6
    v_rcp_f32 v4, v4
    s_nop 0
    v_mul_f32 v120, v120, v4
    v_mul_f32 v121, v121, v4
    v_mul_f32 v122, v122, v4
    v_mul_f32 v123, v123, v4
    v_cvt_pk_bf16_f32 v4, v120, v121
    v_cvt_pk_bf16_f32 v5, v122, v123
    v_cndmask_b32 v136, 0, v4, s[68:69]
    v_cndmask_b32 v137, 0, v5, s[68:69]
    v_cndmask_b32 v138, 0, v4, s[70:71]
    v_cndmask_b32 v139, 0, v5, s[70:71]
    s_waitcnt lgkmcnt(0)
    s_nop 0
    v_mfma_f32_16x16x32_bf16 v[40:43], v[8:11], v[136:139], 0
    v_mfma_f32_16x16x32_bf16 v[44:47], v[12:15], v[136:139], 0
    v_mfma_f32_16x16x32_bf16 v[48:51], v[16:19], v[136:139], 0
    v_mfma_f32_16x16x32_bf16 v[52:55], v[20:23], v[136:139], 0
    v_mfma_f32_16x16x32_bf16 v[56:59], v[24:27], v[136:139], 0
    v_mfma_f32_16x16x32_bf16 v[60:63], v[28:31], v[136:139], 0
    v_mfma_f32_16x16x32_bf16 v[64:67], v[32:35], v[136:139], 0
    v_mfma_f32_16x16x32_bf16 v[68:71], v[36:39], v[136:139], 0
    s_mov_b64 exec, s[78:79]
    v_cvt_pk_bf16_f32 v88, v40, v41
    v_cvt_pk_bf16_f32 v89, v42, v43
    v_cvt_pk_bf16_f32 v90, v44, v45
    v_cvt_pk_bf16_f32 v91, v46, v47
    buffer_store_dwordx4 v[88:91], v163, s[80:83], 0 offen offset:0
    v_cvt_pk_bf16_f32 v92, v48, v49
    v_cvt_pk_bf16_f32 v93, v50, v51
    v_cvt_pk_bf16_f32 v94, v52, v53
    v_cvt_pk_bf16_f32 v95, v54, v55
    buffer_store_dwordx4 v[92:95], v163, s[80:83], 0 offen offset:64
    v_cvt_pk_bf16_f32 v96, v56, v57
    v_cvt_pk_bf16_f32 v97, v58, v59
    v_cvt_pk_bf16_f32 v98, v60, v61
    v_cvt_pk_bf16_f32 v99, v62, v63
    buffer_store_dwordx4 v[96:99], v163, s[80:83], 0 offen offset:128
    v_cvt_pk_bf16_f32 v100, v64, v65
    v_cvt_pk_bf16_f32 v101, v66, v67
    v_cvt_pk_bf16_f32 v102, v68, v69
    v_cvt_pk_bf16_f32 v103, v70, v71
    buffer_store_dwordx4 v[100:103], v163, s[80:83], 0 offen offset:192
    s_or_b32 s27, s2, s6
    s_cmp_eq_u32 s27, 0
    s_cbranch_scc0 sk_122
    s_add_u32 s27, s98, 1
    v_mov_b32 v4, 0
    v_mov_b32 v5, s27
    s_mov_b64 exec, 1
    global_store_dword v4, v5, s[4:5]
sk_122:
    s_endpgm
one_121:
    v_add_u32 v3, 81920, v157
    v_mov_b32 v96, 0
    v_mov_b32 v97, 0
    v_mov_b32 v98, 0
    v_mov_b32 v99, 0
    v_mov_b32 v138, v161
    v_mov_b32 v139, v167
    s_setprio 2
    s_waitcnt vmcnt(0)
    s_barrier
    ds_read_b64 v[8:9], v166 offset:0
    ds_read_b64 v[10:11], v166 offset:320
    ds_read_b64 v[12:13], v166 offset:2560
    ds_read_b64 v[14:15], v166 offset:2880
    ds_read_b64 v[16:17], v166 offset:5120
    ds_read_b64 v[18:19], v166 offset:5440
    ds_read_b64 v[20:21], v166 offset:7680
    ds_read_b64 v[22:23], v166 offset:8000
    ds_read_b128 v[40:43], v157 offset:0
    ds_read_b128 v[44:47], v157 offset:1024
    ds_read_b128 v[48:51], v157 offset:2048
    ds_read_b128 v[52:55], v157 offset:3072
    s_waitcnt lgkmcnt(10)
    v_mfma_f32_16x16x32_bf16 v[88:91], v[8:11], v[8:11], 0
    s_waitcnt lgkmcnt(8)
    v_mfma_f32_16x16x32_bf16 v[88:91], v[12:15], v[12:15], v[88:91]
    ds_read_b128 v[56:59], v157 offset:4096
    s_waitcnt lgkmcnt(7)
    v_mfma_f32_16x16x32_bf16 v[88:91], v[16:19], v[16:19], v[88:91]
    ds_read_b128 v[60:63], v157 offset:5120
    s_waitcnt lgkmcnt(6)
    v_mfma_f32_16x16x32_bf16 v[88:91], v[20:23], v[20:23], v[88:91]
    ds_read_b128 v[64:67], v157 offset:6144
    v_smfmac_f32_16x16x64_bf16 v[96:99], v[148:151], v[8:15], v156
    ds_read_b128 v[68:71], v157 offset:7168
    v_smfmac_f32_16x16x64_bf16 v[96:99], v[152:155], v[16:23], v156
    s_waitcnt lgkmcnt(7)
    v_mfma_f32_16x16x32_bf16 v[72:75], v[40:43], v[8:11], 0
    ds_read_b128 v[24:27], v157 offset:8192
    s_waitcnt lgkmcnt(7)
    v_mfma_f32_16x16x32_bf16 v[72:75], v[44:47], v[12:15], v[72:75]
    ds_read_b128 v[28:31], v157 offset:9216
    ds_read_b128 v[32:35], v157 offset:10240
    s_waitcnt lgkmcnt(8)
    v_mfma_f32_16x16x32_bf16 v[72:75], v[48:51], v[16:19], v[72:75]
    ds_read_b128 v[36:39], v157 offset:11264
    v_cndmask_b32 v4, v88, v89, s[60:61]
    s_waitcnt lgkmcnt(8)
    v_mfma_f32_16x16x32_bf16 v[72:75], v[52:55], v[20:23], v[72:75]
    v_add_f32 v6, v96, v97
    v_cndmask_b32 v4, v4, v90, s[62:63]
    v_mul_f32 v96, v6, v6
    s_waitcnt lgkmcnt(7)
    v_mfma_f32_16x16x32_bf16 v[80:83], v[56:59], v[8:11], 0
    ds_read_b128 v[40:43], v157 offset:12288
    s_waitcnt lgkmcnt(7)
    v_mfma_f32_16x16x32_bf16 v[80:83], v[60:63], v[12:15], v[80:83]
    ds_read_b128 v[44:47], v157 offset:13312
    ds_read_b128 v[48:51], v157 offset:14336
    s_waitcnt lgkmcnt(8)
    v_mfma_f32_16x16x32_bf16 v[80:83], v[64:67], v[16:19], v[80:83]
    ds_read_b128 v[52:55], v157 offset:15360
    v_cvt_pk_bf16_f32 v104, v72, v73
    v_cvt_pk_bf16_f32 v105, v74, v75
    s_waitcnt lgkmcnt(8)
    v_mfma_f32_16x16x32_bf16 v[80:83], v[68:71], v[20:23], v[80:83]
    v_cndmask_b32 v4, v4, v91, s[64:65]
    v_mul_f32 v96, s76, v96
    v_fma_f32 v4, v4, s75, v96
    v_max_f32 v4, 0, v4
    s_waitcnt lgkmcnt(7)
    v_mfma_f32_16x16x32_bf16 v[72:75], v[24:27], v[8:11], 0
    ds_read_b128 v[56:59], v157 offset:16384
    s_waitcnt lgkmcnt(7)
    v_mfma_f32_16x16x32_bf16 v[72:75], v[28:31], v[12:15], v[72:75]
    ds_read_b128 v[60:63], v157 offset:17408
    ds_read_b128 v[64:67], v157 offset:18432
    s_waitcnt lgkmcnt(8)
    v_mfma_f32_16x16x32_bf16 v[72:75], v[32:35], v[16:19], v[72:75]
    ds_read_b128 v[68:71], v157 offset:19456
    v_cvt_pk_bf16_f32 v106, v80, v81
    s_waitcnt lgkmcnt(8)
    v_mfma_f32_16x16x32_bf16 v[72:75], v[36:39], v[20:23], v[72:75]
    v_cvt_pk_bf16_f32 v107, v82, v83
    v_add_f32 v4, s74, v4
    v_rsq_f32 v4, v4
    v_mfma_f32_16x16x32_bf16 v[112:115], v[8:11], v[104:107], 0
    s_waitcnt lgkmcnt(7)
    v_mfma_f32_16x16x32_bf16 v[80:83], v[40:43], v[8:11], 0
    ds_read_b128 v[24:27], v157 offset:20480
    s_waitcnt lgkmcnt(7)
    v_mfma_f32_16x16x32_bf16 v[80:83], v[44:47], v[12:15], v[80:83]
    ds_read_b128 v[28:31], v157 offset:21504
    ds_read_b128 v[32:35], v157 offset:22528
    s_waitcnt lgkmcnt(8)
    v_mfma_f32_16x16x32_bf16 v[80:83], v[48:51], v[16:19], v[80:83]
    ds_read_b128 v[36:39], v157 offset:23552
    v_cvt_pk_bf16_f32 v104, v72, v73
    s_waitcnt lgkmcnt(8)
    v_mfma_f32_16x16x32_bf16 v[80:83], v[52:55], v[20:23], v[80:83]
    v_cvt_pk_bf16_f32 v105, v74, v75
    ds_write_b32 v158, v4 offset:0
    s_waitcnt lgkmcnt(8)
    v_mfma_f32_16x16x32_bf16 v[72:75], v[56:59], v[8:11], 0
    ds_read_b128 v[40:43], v157 offset:24576
    s_waitcnt lgkmcnt(8)
    v_mfma_f32_16x16x32_bf16 v[72:75], v[60:63], v[12:15], v[72:75]
    ds_read_b128 v[44:47], v157 offset:25600
    ds_read_b128 v[48:51], v157 offset:26624
    s_waitcnt lgkmcnt(9)
    v_mfma_f32_16x16x32_bf16 v[72:75], v[64:67], v[16:19], v[72:75]
    ds_read_b128 v[52:55], v157 offset:27648
    v_cvt_pk_bf16_f32 v106, v80, v81
    v_cvt_pk_bf16_f32 v107, v82, v83
    s_waitcnt lgkmcnt(9)
    v_mfma_f32_16x16x32_bf16 v[72:75], v[68:71], v[20:23], v[72:75]
    ds_read_b32 v144, v159 offset:0
    ds_read_b128 v[120:123], v160 offset:0
    v_mfma_f32_16x16x32_bf16 v[112:115], v[12:15], v[104:107], v[112:115]
    s_waitcnt lgkmcnt(10)
    v_mfma_f32_16x16x32_bf16 v[80:83], v[24:27], v[8:11], 0
    ds_read_b128 v[56:59], v157 offset:28672
    s_waitcnt lgkmcnt(10)
    v_mfma_f32_16x16x32_bf16 v[80:83], v[28:31], v[12:15], v[80:83]
    ds_read_b128 v[60:63], v157 offset:29696
    s_waitcnt lgkmcnt(10)
    v_mfma_f32_16x16x32_bf16 v[80:83], v[32:35], v[16:19], v[80:83]
    ds_read_b128 v[64:67], v157 offset:30720
    s_waitcnt lgkmcnt(10)
    v_mfma_f32_16x16x32_bf16 v[80:83], v[36:39], v[20:23], v[80:83]
    ds_read_b128 v[68:71], v157 offset:31744
    v_cvt_pk_bf16_f32 v104, v72, v73
    v_cvt_pk_bf16_f32 v105, v74, v75
    s_waitcnt lgkmcnt(9)
    v_mfma_f32_16x16x32_bf16 v[72:75], v[40:43], v[8:11], 0
    ds_read_b128 v[24:27], v3 offset:0
    s_waitcnt lgkmcnt(9)
    v_mfma_f32_16x16x32_bf16 v[72:75], v[44:47], v[12:15], v[72:75]
    ds_read_b128 v[28:31], v3 offset:1024
    s_waitcnt lgkmcnt(9)
    v_mfma_f32_16x16x32_bf16 v[72:75], v[48:51], v[16:19], v[72:75]
    ds_read_b128 v[32:35], v3 offset:2048
    s_waitcnt lgkmcnt(9)
    v_mfma_f32_16x16x32_bf16 v[72:75], v[52:55], v[20:23], v[72:75]
    ds_read_b128 v[36:39], v3 offset:3072
    v_cvt_pk_bf16_f32 v106, v80, v81
    v_cvt_pk_bf16_f32 v107, v82, v83
    s_nop 1
    v_mfma_f32_16x16x32_bf16 v[112:115], v[16:19], v[104:107], v[112:115]
    s_waitcnt lgkmcnt(7)
    v_mfma_f32_16x16x32_bf16 v[80:83], v[56:59], v[8:11], 0
    ds_read_b128 v[40:43], v3 offset:4096
    s_waitcnt lgkmcnt(7)
    v_mfma_f32_16x16x32_bf16 v[80:83], v[60:63], v[12:15], v[80:83]
    ds_read_b128 v[44:47], v3 offset:5120
    s_waitcnt lgkmcnt(7)
    v_mfma_f32_16x16x32_bf16 v[80:83], v[64:67], v[16:19], v[80:83]
    ds_read_b128 v[48:51], v3 offset:6144
    s_waitcnt lgkmcnt(7)
    v_mfma_f32_16x16x32_bf16 v[80:83], v[68:71], v[20:23], v[80:83]
    ds_read_b128 v[52:55], v3 offset:7168
    v_cvt_pk_bf16_f32 v104, v72, v73
    v_cvt_pk_bf16_f32 v105, v74, v75
    s_waitcnt lgkmcnt(7)
    v_mfma_f32_16x16x32_bf16 v[72:75], v[8:11], v[24:27], 0
    ds_read_b128 v[56:59], v3 offset:8192
    s_waitcnt lgkmcnt(7)
    v_mfma_f32_16x16x32_bf16 v[72:75], v[12:15], v[28:31], v[72:75]
    ds_read_b128 v[60:63], v3 offset:9216
    s_waitcnt lgkmcnt(7)
    v_mfma_f32_16x16x32_bf16 v[72:75], v[16:19], v[32:35], v[72:75]
    ds_read_b128 v[64:67], v3 offset:10240
    s_waitcnt lgkmcnt(7)
    v_mfma_f32_16x16x32_bf16 v[72:75], v[20:23], v[36:39], v[72:75]
    ds_read_b128 v[68:71], v3 offset:11264
    v_cvt_pk_bf16_f32 v106, v80, v81
    v_cvt_pk_bf16_f32 v107, v82, v83
    s_nop 1
    v_mfma_f32_16x16x32_bf16 v[112:115], v[20:23], v[104:107], v[112:115]
    ds_read_b64_tr_b16 v[130:131], v162 offset:0
    s_setprio 1
    s_waitcnt lgkmcnt(8)
    v_mfma_f32_16x16x32_bf16 v[80:83], v[8:11], v[40:43], 0
    ds_read_b128 v[24:27], v3 offset:12288
    ds_read_b128 v[28:31], v3 offset:13312
    ds_read_b128 v[32:35], v3 offset:14336
    ds_read_b128 v[36:39], v3 offset:15360
    v_cvt_pk_bf16_f32 v128, v72, v73
    v_cvt_pk_bf16_f32 v129, v74, v75
    v_mul_f32 v112, v112, v120
    v_mul_f32 v113, v113, v121
    v_mul_f32 v114, v114, v122
    s_waitcnt lgkmcnt(11)
    v_mfma_f32_16x16x32_bf16 v[80:83], v[12:15], v[44:47], v[80:83]
    v_mul_f32 v115, v115, v123
    v_max3_f32 v4, v112, v113, v114
    v_max_f32 v4, v4, v115
    v_mov_b32 v5, v4
    s_nop 1
    v_permlane16_swap_b32 v5, v4
    v_max_f32 v4, v4, v5
    v_mul_f32 v4, v4, v144
    v_fma_f32 v112, v112, v144, -v4
    v_fma_f32 v113, v113, v144, -v4
    v_fma_f32 v114, v114, v144, -v4
    v_fma_f32 v115, v115, v144, -v4
    s_waitcnt lgkmcnt(10)
    v_mfma_f32_16x16x32_bf16 v[80:83], v[16:19], v[48:51], v[80:83]
    v_exp_f32 v112, v112
    v_exp_f32 v113, v113
    v_exp_f32 v114, v114
    v_exp_f32 v115, v115
    v_add_f32 v4, v112, v113
    v_add_f32 v5, v114, v115
    v_add_f32 v4, v4, v5
    v_mov_b32 v5, v4
    v_mul_f32 v112, v112, v120
    v_mul_f32 v113, v113, v121
    s_waitcnt lgkmcnt(9)
    v_mfma_f32_16x16x32_bf16 v[80:83], v[20:23], v[52:55], v[80:83]
    v_permlane16_swap_b32 v5, v4
    v_add_f32 v4, v4, v5
    v_rcp_f32 v4, v4
    v_mul_f32 v114, v114, v122
    v_mul_f32 v115, v115, v123
    v_cndmask_b32 v4, 0, v4, s[66:67]
    v_mul_f32 v112, v112, v4
    v_mul_f32 v113, v113, v4
    v_mul_f32 v114, v114, v4
    v_mul_f32 v115, v115, v4
    v_cvt_pk_bf16_f32 v136, v112, v113
    v_cvt_pk_bf16_f32 v137, v114, v115
    s_waitcnt lgkmcnt(4)
    s_nop 0
    v_mfma_f32_16x16x32_bf16 v[120:123], v[128:131], v[136:139], 0
    ds_read_b64_tr_b16 v[130:131], v162 offset:320
    v_mfma_f32_16x16x32_bf16 v[72:75], v[8:11], v[56:59], 0
    ds_read_b128 v[40:43], v3 offset:16384
    v_mfma_f32_16x16x32_bf16 v[72:75], v[12:15], v[60:63], v[72:75]
    ds_read_b128 v[44:47], v3 offset:17408
    ds_read_b128 v[48:51], v3 offset:18432
    v_mfma_f32_16x16x32_bf16 v[72:75], v[16:19], v[64:67], v[72:75]
    ds_read_b128 v[52:55], v3 offset:19456
    v_cvt_pk_bf16_f32 v88, v120, v121
    v_mfma_f32_16x16x32_bf16 v[72:75], v[20:23], v[68:71], v[72:75]
    v_cvt_pk_bf16_f32 v89, v122, v123
    v_cvt_pk_bf16_f32 v128, v80, v81
    v_cvt_pk_bf16_f32 v129, v82, v83
    s_waitcnt lgkmcnt(4)
    s_nop 0
    v_mfma_f32_16x16x32_bf16 v[120:123], v[128:131], v[136:139], 0
    ds_read_b64_tr_b16 v[130:131], v162 offset:2560
    v_mfma_f32_16x16x32_bf16 v[80:83], v[8:11], v[24:27], 0
    ds_read_b128 v[56:59], v3 offset:20480
    v_mfma_f32_16x16x32_bf16 v[80:83], v[12:15], v[28:31], v[80:83]
    ds_read_b128 v[60:63], v3 offset:21504
    ds_read_b128 v[64:67], v3 offset:22528
    v_mfma_f32_16x16x32_bf16 v[80:83], v[16:19], v[32:35], v[80:83]
    ds_read_b128 v[68:71], v3 offset:23552
    v_cvt_pk_bf16_f32 v90, v120, v121
    v_mfma_f32_16x16x32_bf16 v[80:83], v[20:23], v[36:39], v[80:83]
    v_cvt_pk_bf16_f32 v91, v122, v123
    v_cvt_pk_bf16_f32 v128, v72, v73
    v_cvt_pk_bf16_f32 v129, v74, v75
    s_waitcnt lgkmcnt(4)
    s_nop 0
    v_mfma_f32_16x16x32_bf16 v[120:123], v[128:131], v[136:139], 0
    ds_read_b64_tr_b16 v[130:131], v162 offset:2880
    v_mfma_f32_16x16x32_bf16 v[72:75], v[8:11], v[40:43], 0
    ds_read_b128 v[24:27], v3 offset:24576
    v_mfma_f32_16x16x32_bf16 v[72:75], v[12:15], v[44:47], v[72:75]
    ds_read_b128 v[28:31], v3 offset:25600
    ds_read_b128 v[32:35], v3 offset:26624
    v_mfma_f32_16x16x32_bf16 v[72:75], v[16:19], v[48:51], v[72:75]
    ds_read_b128 v[36:39], v3 offset:27648
    v_cvt_pk_bf16_f32 v92, v120, v121
    v_mfma_f32_16x16x32_bf16 v[72:75], v[20:23], v[52:55], v[72:75]
    v_cvt_pk_bf16_f32 v93, v122, v123
    v_cvt_pk_bf16_f32 v128, v80, v81
    v_cvt_pk_bf16_f32 v129, v82, v83
    s_waitcnt lgkmcnt(4)
    s_nop 0
    v_mfma_f32_16x16x32_bf16 v[120:123], v[128:131], v[136:139], 0
    ds_read_b64_tr_b16 v[130:131], v162 offset:5120
    v_mfma_f32_16x16x32_bf16 v[80:83], v[8:11], v[56:59], 0
    ds_read_b128 v[40:43], v3 offset:28672
    v_mfma_f32_16x16x32_bf16 v[80:83], v[12:15], v[60:63], v[80:83]
    ds_read_b128 v[44:47], v3 offset:29696
    ds_read_b128 v[48:51], v3 offset:30720
    v_mfma_f32_16x16x32_bf16 v[80:83], v[16:19], v[64:67], v[80:83]
    ds_read_b128 v[52:55], v3 offset:31744
    v_cvt_pk_bf16_f32 v94, v120, v121
    v_mfma_f32_16x16x32_bf16 v[80:83], v[20:23], v[68:71], v[80:83]
    v_cvt_pk_bf16_f32 v95, v122, v123
    v_cvt_pk_bf16_f32 v128, v72, v73
    v_cvt_pk_bf16_f32 v129, v74, v75
    s_waitcnt lgkmcnt(4)
    s_nop 0
    v_mfma_f32_16x16x32_bf16 v[120:123], v[128:131], v[136:139], 0
    ds_read_b64_tr_b16 v[130:131], v162 offset:5440
    v_mfma_f32_16x16x32_bf16 v[72:75], v[8:11], v[24:27], 0
    s_nop 5
    v_cvt_pk_bf16_f32 v96, v120, v121
    v_cvt_pk_bf16_f32 v97, v122, v123
    v_mfma_f32_16x16x32_bf16 v[72:75], v[12:15], v[28:31], v[72:75]
    v_cvt_pk_bf16_f32 v128, v80, v81
    v_cvt_pk_bf16_f32 v129, v82, v83
    v_mfma_f32_16x16x32_bf16 v[72:75], v[16:19], v[32:35], v[72:75]
    v_mfma_f32_16x16x32_bf16 v[72:75], v[20:23], v[36:39], v[72:75]
    s_waitcnt lgkmcnt(0)
    v_mfma_f32_16x16x32_bf16 v[120:123], v[128:131], v[136:139], 0
    ds_read_b64_tr_b16 v[130:131], v162 offset:7680
    v_mfma_f32_16x16x32_bf16 v[80:83], v[8:11], v[40:43], 0
    v_mov_b32 v32, 0
    v_mov_b32 v33, 0
    v_mfma_f32_16x16x32_bf16 v[80:83], v[12:15], v[44:47], v[80:83]
    v_mov_b32 v34, 0
    v_mov_b32 v35, 0
    v_mfma_f32_16x16x32_bf16 v[80:83], v[16:19], v[48:51], v[80:83]
    v_cvt_pk_bf16_f32 v98, v120, v121
    v_cvt_pk_bf16_f32 v99, v122, v123
    v_mfma_f32_16x16x32_bf16 v[80:83], v[20:23], v[52:55], v[80:83]
    v_cvt_pk_bf16_f32 v128, v72, v73
    v_cvt_pk_bf16_f32 v129, v74, v75
    s_waitcnt lgkmcnt(0)
    s_nop 0
    v_mfma_f32_16x16x32_bf16 v[120:123], v[128:131], v[136:139], 0
    ds_read_b64_tr_b16 v[130:131], v162 offset:8000
    s_setprio 0
    v_mfma_f32_16x16x32_bf16 v[24:27], v[88:91], v[88:91], 0
    v_cvt_pk_bf16_f32 v128, v80, v81
    v_cvt_pk_bf16_f32 v129, v82, v83
    v_mfma_f32_16x16x32_bf16 v[24:27], v[92:95], v[92:95], v[24:27]
    s_nop 1
    v_cvt_pk_bf16_f32 v100, v120, v121
    v_cvt_pk_bf16_f32 v101, v122, v123
    s_waitcnt lgkmcnt(0)
    v_mfma_f32_16x16x32_bf16 v[120:123], v[128:131], v[136:139], 0
    v_mfma_f32_16x16x32_bf16 v[24:27], v[96:99], v[96:99], v[24:27]
    ds_write_b64 v166, v[88:89] offset:0
    ds_write_b64 v166, v[90:91] offset:320
    ds_write_b64 v166, v[92:93] offset:2560
    v_smfmac_f32_16x16x64_bf16 v[32:35], v[148:151], v[88:95], v156
    ds_write_b64 v166, v[94:95] offset:2880
    ds_write_b64 v166, v[96:97] offset:5120
    ds_write_b64 v166, v[98:99] offset:5440
    v_cvt_pk_bf16_f32 v102, v120, v121
    v_cvt_pk_bf16_f32 v103, v122, v123
    s_nop 1
    v_mfma_f32_16x16x32_bf16 v[24:27], v[100:103], v[100:103], v[24:27]
    v_smfmac_f32_16x16x64_bf16 v[32:35], v[152:155], v[96:103], v156
    ds_write_b64 v166, v[100:101] offset:7680
    ds_write_b64 v166, v[102:103] offset:8000
    v_mov_b32 v42, 0
    v_mov_b32 v43, 0
    v_mov_b32 v46, 0
    v_mov_b32 v47, 0
    v_mov_b32 v50, 0
    v_mov_b32 v51, 0
    v_mov_b32 v54, 0
    v_mov_b32 v55, 0
    v_mov_b32 v58, 0
    v_mov_b32 v59, 0
    v_mov_b32 v62, 0
    v_mov_b32 v63, 0
    v_mov_b32 v66, 0
    v_mov_b32 v67, 0
    v_mov_b32 v70, 0
    v_mov_b32 v71, 0
    ds_read_b64_tr_b16 v[40:41], v162 offset:0
    ds_read_b64_tr_b16 v[44:45], v162 offset:320
    v_cndmask_b32 v4, v24, v25, s[60:61]
    v_add_f32 v5, v32, v33
    v_add_f32 v34, v34, v35
    v_cndmask_b32 v4, v4, v26, s[62:63]
    v_mul_f32 v32, v5, v5
    v_cndmask_b32 v4, v4, v27, s[64:65]
    v_mul_f32 v32, s76, v32
    v_fma_f32 v4, v4, s75, v32
    v_max_f32 v4, 0, v4
    v_add_f32 v4, s74, v4
    v_fma_f32 v34, v5, s72, v34
    v_rsq_f32 v4, v4
    v_mul_f32 v34, s73, v34
    v_mul_f32 v4, v4, v34
    ds_write_b32 v158, v4 offset:0
    ds_read_b128 v[120:123], v164
    ds_read_b128 v[124:127], v165
    ds_read_b64_tr_b16 v[48:49], v162 offset:2560
    ds_read_b64_tr_b16 v[52:53], v162 offset:2880
    s_waitcnt lgkmcnt(7)
    ds_read_b64_tr_b16 v[56:57], v162 offset:5120
    ds_read_b64_tr_b16 v[60:61], v162 offset:5440
    ds_read_b64_tr_b16 v[64:65], v162 offset:7680
    ds_read_b64_tr_b16 v[68:69], v162 offset:8000
    s_waitcnt lgkmcnt(6)
    v_max3_f32 v4, v120, v121, v122
    v_max3_f32 v5, v123, v124, v125
    v_max3_f32 v4, v4, v126, v127
    v_max_f32 v4, v4, v5
    v_sub_f32 v120, v120, v4
    v_sub_f32 v121, v121, v4
    v_sub_f32 v122, v122, v4
    v_sub_f32 v123, v123, v4
    v_sub_f32 v124, v124, v4
    v_sub_f32 v125, v125, v4
    v_sub_f32 v126, v126, v4
    v_sub_f32 v127, v127, v4
    v_exp_f32 v120, v120
    v_exp_f32 v121, v121
    v_exp_f32 v122, v122
    v_exp_f32 v123, v123
    v_exp_f32 v124, v124
    v_exp_f32 v125, v125
    v_exp_f32 v126, v126
    v_exp_f32 v127, v127
    v_add_f32 v4, v120, v121
    v_add_f32 v5, v122, v123
    v_add_f32 v6, v124, v125
    v_add_f32 v7, v126, v127
    v_add_f32 v4, v4, v5
    v_add_f32 v6, v6, v7
    v_add_f32 v4, v4, v6
    v_rcp_f32 v4, v4
    s_nop 0
    v_mul_f32 v120, v120, v4
    v_mul_f32 v121, v121, v4
    v_mul_f32 v122, v122, v4
    v_mul_f32 v123, v123, v4
    v_cvt_pk_bf16_f32 v4, v120, v121
    v_cvt_pk_bf16_f32 v5, v122, v123
    v_cndmask_b32 v136, 0, v4, s[68:69]
    v_cndmask_b32 v137, 0, v5, s[68:69]
    v_cndmask_b32 v138, 0, v4, s[70:71]
    v_cndmask_b32 v139, 0, v5, s[70:71]
    s_waitcnt lgkmcnt(0)
    s_nop 0
    v_mfma_f32_16x16x32_bf16 v[8:11], v[40:43], v[136:139], 0
    v_mfma_f32_16x16x32_bf16 v[12:15], v[44:47], v[136:139], 0
    v_mfma_f32_16x16x32_bf16 v[16:19], v[48:51], v[136:139], 0
    v_mfma_f32_16x16x32_bf16 v[20:23], v[52:55], v[136:139], 0
    v_mfma_f32_16x16x32_bf16 v[24:27], v[56:59], v[136:139], 0
    v_mfma_f32_16x16x32_bf16 v[28:31], v[60:63], v[136:139], 0
    v_mfma_f32_16x16x32_bf16 v[32:35], v[64:67], v[136:139], 0
    v_mfma_f32_16x16x32_bf16 v[36:39], v[68:71], v[136:139], 0
    s_mov_b64 exec, s[78:79]
    v_cvt_pk_bf16_f32 v88, v8, v9
    v_cvt_pk_bf16_f32 v89, v10, v11
    v_cvt_pk_bf16_f32 v90, v12, v13
    v_cvt_pk_bf16_f32 v91, v14, v15
    buffer_store_dwordx4 v[88:91], v163, s[80:83], 0 offen offset:0
    v_cvt_pk_bf16_f32 v92, v16, v17
    v_cvt_pk_bf16_f32 v93, v18, v19
    v_cvt_pk_bf16_f32 v94, v20, v21
    v_cvt_pk_bf16_f32 v95, v22, v23
    buffer_store_dwordx4 v[92:95], v163, s[80:83], 0 offen offset:64
    v_cvt_pk_bf16_f32 v96, v24, v25
    v_cvt_pk_bf16_f32 v97, v26, v27
    v_cvt_pk_bf16_f32 v98, v28, v29
    v_cvt_pk_bf16_f32 v99, v30, v31
    buffer_store_dwordx4 v[96:99], v163, s[80:83], 0 offen offset:128
    v_cvt_pk_bf16_f32 v100, v32, v33
    v_cvt_pk_bf16_f32 v101, v34, v35
    v_cvt_pk_bf16_f32 v102, v36, v37
    v_cvt_pk_bf16_f32 v103, v38, v39
    buffer_store_dwordx4 v[100:103], v163, s[80:83], 0 offen offset:192
    s_endpgm
k_nb:
    s_cmp_eq_u32 s6, 10
    s_cbranch_scc0 sk_123
    v_lshlrev_b32 v32, 3, v2
    s_lshl_b32 s27, s8, 10
    s_add_u32 s27, s27, 122880
    v_add_u32 v32, s27, v32
    s_mov_b64 exec, 0xff
    s_branch se_126
sp_124:
    s_sleep 8
se_126:
    global_load_dword v33, v32, s[4:5] sc1
    s_add_u32 s19, s19, 1
    s_cmp_ge_u32 s19, 4194304
    s_cbranch_scc1 so_125
    s_waitcnt vmcnt(0)
    v_subrev_u32 v34, s53, v33
    v_cmp_le_u32 vcc, 16, v34
    s_cbranch_vccnz sp_124
so_125:
    s_waitcnt vmcnt(0)
    v_readfirstlane_b32 s27, v33
    s_nop 1
    v_cmp_ne_u32 vcc, s27, v33
    s_mov_b64 exec, 1
    s_cmp_eq_u64 vcc, 0
    s_cselect_b32 s27, 1, 0
    v_mov_b32 v36, s27
    v_mov_b32 v37, 0
    v_mov_b32 v38, 0
    v_mov_b32 v39, 0
    ds_write_b128 v2, v[36:39] offset:39936
    s_mov_b64 exec, -1
sk_123:
    s_cmp_ge_u32 s2, 254
    s_cbranch_scc1 k_join
    s_cmp_lt_u32 s7, 3
    s_cbranch_scc0 sk_127
    s_mul_i32 s27, s7, 12288
    s_add_u32 s16, s12, s27
    s_addc_u32 s17, s13, 0
    s_add_u32 s16, s16, 2621440
    s_addc_u32 s17, s17, 0
    global_load_dwordx4 v[28:31], v23, s[16:17] sc1
    s_add_u32 s16, s16, 36864
    s_addc_u32 s17, s17, 0
    global_load_dwordx4 v[28:31], v23, s[16:17] sc1
    s_add_u32 s16, s16, 36864
    s_addc_u32 s17, s17, 0
    global_load_dwordx4 v[28:31], v23, s[16:17] sc1
    v_lshrrev_b32 v22, 1, v2
    global_load_dwordx2 v[28:29], v22, s[36:37] sc1
sk_127:
    s_cmp_eq_u32 s6, 0
    s_cbranch_scc0 sk_128
    s_branch se_131
sp_129:
    s_sleep 1
se_131:
    global_load_dword v42, v40, s[4:5] sc1
    global_load_dword v43, v41, s[4:5] sc1
    s_add_u32 s19, s19, 1
    s_cmp_ge_u32 s19, 4194304
    s_cbranch_scc1 so_130
    s_waitcnt vmcnt(0)
    v_xor_b32 v42, s53, v42
    v_xor_b32 v43, s53, v43
    v_or_b32 v42, v42, v43
    v_cmp_ne_u32 vcc, 0, v42
    s_cbranch_vccnz sp_129
so_130:
    s_waitcnt vmcnt(0)
sk_128:
    s_barrier
    s_add_u32 m0, s42, 81920
    s_add_u32 s16, s12, 0
    s_addc_u32 s17, s13, 0
    global_load_lds_dwordx4 v23, s[16:17] sc1
    s_add_u32 m0, s42, 94208
    s_add_u32 s16, s12, 12288
    s_addc_u32 s17, s13, 0
    global_load_lds_dwordx4 v23, s[16:17] sc1
    s_add_u32 m0, s42, 106496
    s_add_u32 s16, s12, 24576
    s_addc_u32 s17, s13, 0
    global_load_lds_dwordx4 v23, s[16:17] sc1
    s_cmp_lt_u32 s6, 4
    s_cselect_b32 s27, 122880, 0
    s_add_u32 s27, s27, s42
    s_sub_u32 m0, s27, 4096
    s_add_u32 s16, s12, 36864
    s_addc_u32 s17, s13, 0
    global_load_lds_dwordx4 v23, s[16:17] sc1
    s_add_u32 m0, s42, 8192
    s_add_u32 s16, s12, 49152
    s_addc_u32 s17, s13, 0
    global_load_lds_dwordx4 v23, s[16:17] sc1
    s_add_u32 m0, s42, 20480
    s_add_u32 s16, s12, 61440
    s_addc_u32 s17, s13, 0
    global_load_lds_dwordx4 v23, s[16:17] sc1
    s_add_u32 m0, s42, 32768
    s_add_u32 s16, s12, 73728
    s_addc_u32 s17, s13, 0
    s_cmp_lt_u32 s6, 7
    s_cbranch_scc0 sk_132
    global_load_lds_dwordx4 v23, s[16:17] sc1
sk_132:
    s_cmp_lt_u32 s7, 3
    s_cbranch_scc0 sk_133
    v_mov_b32 v24, -1
    v_mov_b32 v25, -1
    v_mov_b32 v26, -1
    v_mov_b32 v27, -1
    s_mul_i32 s27, s7, 12288
    v_add_u32 v22, s27, v23
    s_mul_i32 s28, s7, 12
    s_add_u32 s28, s28, s6
    s_add_u32 s16, s14, 13107200
    s_addc_u32 s17, s15, 0
    global_store_dwordx4 v22, v[24:27], s[16:17] sc1
    s_add_u32 s16, s14, 15728640
    s_addc_u32 s17, s15, 0
    global_store_dwordx4 v22, v[24:27], s[16:17] sc1
    s_add_u32 s16, s14, 13144064
    s_addc_u32 s17, s15, 0
    global_store_dwordx4 v22, v[24:27], s[16:17] sc1
    s_add_u32 s16, s14, 15765504
    s_addc_u32 s17, s15, 0
    global_store_dwordx4 v22, v[24:27], s[16:17] sc1
    s_cmp_lt_u32 s28, 8
    s_cbranch_scc0 sk_134
    s_add_u32 s16, s14, 13180928
    s_addc_u32 s17, s15, 0
    global_store_dwordx4 v22, v[24:27], s[16:17] sc1
    s_add_u32 s16, s14, 15802368
    s_addc_u32 s17, s15, 0
    global_store_dwordx4 v22, v[24:27], s[16:17] sc1
sk_134:
sk_133:
    s_branch k_join
k_w:
    s_waitcnt lgkmcnt(0)
    s_load_dword s98, s[4:5], 0
    s_lshr_b32 s7, s2, 5
    s_and_b32 s8, s2, 7
    s_lshl_b32 s8, s8, 2
    s_bfe_u32 s3, s2, 0x20003
    s_add_u32 s8, s8, s3
    s_lshl_b32 s11, s6, 3
    s_add_u32 s11, s11, s7
    s_lshl_b32 s27, s11, 7
    v_lshl_add_u32 v17, v16, 1, s27
    v_add_u32 v18, 10240, v17
    s_mov_b32 s44, s46
    s_mov_b32 s45, s47
    s_mov_b32 s46, 20000
    s_mov_b32 s47, 0x20000
    buffer_load_ushort v13, v17, s[44:47], 0 offen
    buffer_load_ushort v14, v18, s[44:47], 0 offen
    s_waitcnt lgkmcnt(0)
    s_mul_i32 s53, s98, 0x9E3779B1
    s_lshr_b32 s27, s53, 15
    s_xor_b32 s53, s53, s27
    s_mul_i32 s53, s53, 0x85EBCA6B
    s_add_u32 s53, s53, 0x632BE5AB
    s_cmp_eq_u32 s2, 253
    s_cbranch_scc1 k_h0
    s_cmp_eq_u32 s6, 11
    s_cbranch_scc0 sk_135
    s_getreg_b32 s27, hwreg(HW_REG_XCC_ID)
    s_and_b32 s27, s27, 15
    s_add_u32 s27, s27, s53
    v_mov_b32 v21, s27
    s_lshl_b32 s27, s8, 3
    s_add_u32 s27, s27, s7
    s_lshl_b32 s27, s27, 7
    s_add_u32 s27, s27, 122880
    v_mov_b32 v20, s27
    s_mov_b64 exec, 1
    global_store_dword v20, v21, s[4:5] sc1
    s_mov_b64 exec, -1
sk_135:
    s_mov_b32 s22, 0x55555555
    s_mov_b32 s23, 0x55555555
    s_lshl_b32 s27, s11, 9
    v_lshl_add_u32 v0, v16, 3, s27
    s_mul_i32 s27, s8, 81920
    s_add_u32 s12, s4, s27
    s_addc_u32 s13, s5, 0
    s_add_u32 s12, s12, 2097152
    s_addc_u32 s13, s13, 0
    s_add_u32 s14, s12, 7864320
    s_addc_u32 s15, s13, 0
    s_lshl_b32 s27, s8, 10
    s_and_b32 s30, s6, 1
    s_lshl_b32 s30, s30, 9
    s_add_u32 s27, s27, s30
    s_add_u32 s36, s4, s27
    s_addc_u32 s37, s5, 0
    s_add_u32 s36, s36, 262144
    s_addc_u32 s37, s37, 0
    s_lshr_b32 s27, s6, 1
    s_lshl_b32 s27, s27, 3
    s_add_u32 s27, s27, s7
    s_lshl_b32 s27, s27, 2
    s_add_u32 s38, s36, s27
    s_addc_u32 s39, s37, 0
    v_bfe_u32 v40, v16, 4, 1
    v_bfe_u32 v41, v16, 3, 1
    v_bfe_u32 v42, v16, 2, 1
    v_mov_b32 v43, 0x3f80
    v_cmp_eq_u32 vcc, v40, v41
    s_nop 1
    v_cndmask_b32 v43, 0, v43, vcc
    v_cmp_eq_u32 vcc, 0, v42
    s_nop 1
    v_cndmask_b32 v8, 0, v43, vcc
    v_cndmask_b32 v9, 0, v43, vcc
    v_cndmask_b32 v10, v43, 0, vcc
    v_cndmask_b32 v11, v43, 0, vcc
    v_and_b32 v40, 3, v16
    v_add_u32 v41, 1, v40
    v_and_b32 v41, 3, v41
    v_lshl_or_b32 v40, v41, 2, v40
    s_mov_b32 s27, 0x11111111
    v_mul_lo_u32 v12, v40, s27
    s_mov_b32 s18, 0
    s_mov_b32 s24, 0
    v_lshlrev_b32 v40, 3, v2
    v_add_u32 v40, 20480, v40
    v_add_u32 v41, 7808, v40
    s_lshl_b32 s42, s6, 10
    v_add_u32 v23, s42, v2
    s_sub_u32 s60, s2, 254
    s_lshl_b32 s61, s60, 4
    s_add_u32 s62, s0, s61
    s_addc_u32 s63, s1, 0
    s_load_dwordx4 s[64:67], s[62:63], 32
    v_and_b32 v49, 63, v48
    v_lshrrev_b32 v50, 4, v49
    v_and_b32 v51, 15, v49
    v_xor_b32 v52, v51, v50
    v_lshlrev_b32 v52, 4, v52
    v_lshl_add_u32 v52, v50, 8, v52
    v_lshlrev_b32 v53, 2, v48
    v_add_u32 v53, 73728, v53
    v_mov_b32 v54, 0
    ds_write_b32 v53, v54
    s_mov_b32 s68, s6
    s_waitcnt lgkmcnt(0)
wd_141:
    s_lshl_b32 s69, s68, 10
    s_add_u32 s70, s64, s69
    s_addc_u32 s71, s65, 0
    s_add_u32 s72, s66, s69
    s_addc_u32 s73, s67, 0
    s_lshl_b32 s74, s68, 5
    s_and_b32 s74, s74, 0xc0
    v_xor_b32 v53, s74, v52
    s_add_u32 m0, s69, 40960
    s_nop 0
    global_load_lds_dwordx4 v53, s[70:71]
    s_add_u32 m0, s69, 122880
    s_nop 0
    global_load_lds_dwordx4 v53, s[72:73]
    s_add_u32 s68, s68, 12
    s_cmp_lt_u32 s68, 32
    s_cbranch_scc1 wd_141
    v_lshrrev_b32 v52, 2, v51
    v_and_b32 v53, 3, v51
    v_lshl_add_u32 v54, v52, 3, v53
    v_lshlrev_b32 v54, 8, v54
    v_xor_b32 v55, v50, v51
    v_lshl_add_u32 v54, v55, 4, v54
    v_add_u32 v54, 40960, v54
    s_lshr_b32 s68, s6, 1
    s_and_b32 s69, s6, 1
    s_waitcnt vmcnt(0)
    s_barrier
    s_cmp_ge_u32 s6, 8
    s_cbranch_scc1 k_wf
    v_xor_b32 v161, 64, v54
    v_xor_b32 v162, 128, v54
    v_xor_b32 v163, 192, v54
    v_mov_b32 v160, v54
    s_cmp_eq_u32 s60, 0
    s_cbranch_scc0 w1_136
    s_lshl_b32 s70, s68, 13
    s_lshl_b32 s71, s69, 10
    s_add_u32 s70, s70, s71
    s_add_u32 s70, s70, 81920
    v_add_u32 v55, s70, v160
    ds_read_b128 v[88:91], v55
    v_add_u32 v55, s70, v161
    ds_read_b128 v[92:95], v55
    v_add_u32 v55, s70, v162
    ds_read_b128 v[96:99], v55
    v_add_u32 v55, s70, v163
    ds_read_b128 v[100:103], v55
    s_branch w2_137
w1_136:
    v_lshl_add_u32 v55, v50, 2, v52
    s_lshl_b32 s70, s68, 2
    v_add_u32 v53, s70, v53
    v_xor_b32 v53, v53, v55
    v_lshl_add_u32 v55, v50, 3, v52
    v_lshlrev_b32 v55, 8, v55
    v_lshl_add_u32 v55, v53, 4, v55
    s_lshl_b32 s70, s69, 3
    s_add_u32 s70, s70, 122880
    v_add_u32 v55, s70, v55
    ds_read_b64_tr_b16 v[88:89], v55 offset:0
    ds_read_b64_tr_b16 v[90:91], v55 offset:1024
    ds_read_b64_tr_b16 v[92:93], v55 offset:8192
    ds_read_b64_tr_b16 v[94:95], v55 offset:9216
    ds_read_b64_tr_b16 v[96:97], v55 offset:16384
    ds_read_b64_tr_b16 v[98:99], v55 offset:17408
    ds_read_b64_tr_b16 v[100:101], v55 offset:24576
    ds_read_b64_tr_b16 v[102:103], v55 offset:25600
w2_137:
    ds_read_b128 v[56:59], v160 offset:0
    ds_read_b128 v[60:63], v161 offset:0
    ds_read_b128 v[64:67], v162 offset:0
    ds_read_b128 v[68:71], v163 offset:0
    ds_read_b128 v[72:75], v160 offset:1024
    ds_read_b128 v[76:79], v161 offset:1024
    ds_read_b128 v[80:83], v162 offset:1024
    ds_read_b128 v[84:87], v163 offset:1024
    s_waitcnt lgkmcnt(4)
    v_mfma_f32_16x16x32_bf16 v[104:107], v[56:59], v[88:91], 0
    v_mfma_f32_16x16x32_bf16 v[104:107], v[60:63], v[92:95], v[104:107]
    v_mfma_f32_16x16x32_bf16 v[104:107], v[64:67], v[96:99], v[104:107]
    v_mfma_f32_16x16x32_bf16 v[104:107], v[68:71], v[100:103], v[104:107]
    ds_read_b128 v[56:59], v160 offset:8192
    ds_read_b128 v[60:63], v161 offset:8192
    ds_read_b128 v[64:67], v162 offset:8192
    ds_read_b128 v[68:71], v163 offset:8192
    s_waitcnt lgkmcnt(4)
    v_mfma_f32_16x16x32_bf16 v[108:111], v[72:75], v[88:91], 0
    v_mfma_f32_16x16x32_bf16 v[108:111], v[76:79], v[92:95], v[108:111]
    v_mfma_f32_16x16x32_bf16 v[108:111], v[80:83], v[96:99], v[108:111]
    v_mfma_f32_16x16x32_bf16 v[108:111], v[84:87], v[100:103], v[108:111]
    ds_read_b128 v[72:75], v160 offset:9216
    ds_read_b128 v[76:79], v161 offset:9216
    ds_read_b128 v[80:83], v162 offset:9216
    ds_read_b128 v[84:87], v163 offset:9216
    s_waitcnt lgkmcnt(4)
    v_mfma_f32_16x16x32_bf16 v[112:115], v[56:59], v[88:91], 0
    v_mfma_f32_16x16x32_bf16 v[112:115], v[60:63], v[92:95], v[112:115]
    v_mfma_f32_16x16x32_bf16 v[112:115], v[64:67], v[96:99], v[112:115]
    v_mfma_f32_16x16x32_bf16 v[112:115], v[68:71], v[100:103], v[112:115]
    ds_read_b128 v[56:59], v160 offset:16384
    ds_read_b128 v[60:63], v161 offset:16384
    ds_read_b128 v[64:67], v162 offset:16384
    ds_read_b128 v[68:71], v163 offset:16384
    s_waitcnt lgkmcnt(4)
    v_mfma_f32_16x16x32_bf16 v[116:119], v[72:75], v[88:91], 0
    v_mfma_f32_16x16x32_bf16 v[116:119], v[76:79], v[92:95], v[116:119]
    v_mfma_f32_16x16x32_bf16 v[116:119], v[80:83], v[96:99], v[116:119]
    v_mfma_f32_16x16x32_bf16 v[116:119], v[84:87], v[100:103], v[116:119]
    ds_read_b128 v[72:75], v160 offset:17408
    ds_read_b128 v[76:79], v161 offset:17408
    ds_read_b128 v[80:83], v162 offset:17408
    ds_read_b128 v[84:87], v163 offset:17408
    s_waitcnt lgkmcnt(4)
    v_mfma_f32_16x16x32_bf16 v[120:123], v[56:59], v[88:91], 0
    v_mfma_f32_16x16x32_bf16 v[120:123], v[60:63], v[92:95], v[120:123]
    v_mfma_f32_16x16x32_bf16 v[120:123], v[64:67], v[96:99], v[120:123]
    v_mfma_f32_16x16x32_bf16 v[120:123], v[68:71], v[100:103], v[120:123]
    ds_read_b128 v[56:59], v160 offset:24576
    ds_read_b128 v[60:63], v161 offset:24576
    ds_read_b128 v[64:67], v162 offset:24576
    ds_read_b128 v[68:71], v163 offset:24576
    s_waitcnt lgkmcnt(4)
    v_mfma_f32_16x16x32_bf16 v[124:127], v[72:75], v[88:91], 0
    v_mfma_f32_16x16x32_bf16 v[124:127], v[76:79], v[92:95], v[124:127]
    v_mfma_f32_16x16x32_bf16 v[124:127], v[80:83], v[96:99], v[124:127]
    v_mfma_f32_16x16x32_bf16 v[124:127], v[84:87], v[100:103], v[124:127]
    ds_read_b128 v[72:75], v160 offset:25600
    ds_read_b128 v[76:79], v161 offset:25600
    ds_read_b128 v[80:83], v162 offset:25600
    ds_read_b128 v[84:87], v163 offset:25600
    s_waitcnt lgkmcnt(4)
    v_mfma_f32_16x16x32_bf16 v[128:131], v[56:59], v[88:91], 0
    v_mfma_f32_16x16x32_bf16 v[128:131], v[60:63], v[92:95], v[128:131]
    v_mfma_f32_16x16x32_bf16 v[128:131], v[64:67], v[96:99], v[128:131]
    v_mfma_f32_16x16x32_bf16 v[128:131], v[68:71], v[100:103], v[128:131]
    s_waitcnt lgkmcnt(0)
    v_mfma_f32_16x16x32_bf16 v[132:135], v[72:75], v[88:91], 0
    v_mfma_f32_16x16x32_bf16 v[132:135], v[76:79], v[92:95], v[132:135]
    v_mfma_f32_16x16x32_bf16 v[132:135], v[80:83], v[96:99], v[132:135]
    v_mfma_f32_16x16x32_bf16 v[132:135], v[84:87], v[100:103], v[132:135]
    v_add_f32 v53, v104, v105
    v_add_f32 v53, v53, v106
    v_add_f32 v53, v53, v107
    v_add_f32 v53, v53, v108
    v_add_f32 v53, v53, v109
    v_add_f32 v53, v53, v110
    v_add_f32 v53, v53, v111
    v_add_f32 v53, v53, v112
    v_add_f32 v53, v53, v113
    v_add_f32 v53, v53, v114
    v_add_f32 v53, v53, v115
    v_add_f32 v53, v53, v116
    v_add_f32 v53, v53, v117
    v_add_f32 v53, v53, v118
    v_add_f32 v53, v53, v119
    v_add_f32 v53, v53, v120
    v_add_f32 v53, v53, v121
    v_add_f32 v53, v53, v122
    v_add_f32 v53, v53, v123
    v_add_f32 v53, v53, v124
    v_add_f32 v53, v53, v125
    v_add_f32 v53, v53, v126
    v_add_f32 v53, v53, v127
    v_add_f32 v53, v53, v128
    v_add_f32 v53, v53, v129
    v_add_f32 v53, v53, v130
    v_add_f32 v53, v53, v131
    v_add_f32 v53, v53, v132
    v_add_f32 v53, v53, v133
    v_add_f32 v53, v53, v134
    v_add_f32 v53, v53, v135
    v_mov_b32 v55, v53
    s_nop 1
    v_permlane16_swap_b32 v55, v53
    v_add_f32 v53, v53, v55
    v_mov_b32 v55, v53
    s_nop 1
    v_permlane32_swap_b32 v55, v53
    v_add_f32 v53, v53, v55
    v_mul_f32 v53, 0x3c000000, v53
    v_sub_f32 v104, v104, v53
    v_sub_f32 v105, v105, v53
    v_sub_f32 v106, v106, v53
    v_sub_f32 v107, v107, v53
    v_sub_f32 v108, v108, v53
    v_sub_f32 v109, v109, v53
    v_sub_f32 v110, v110, v53
    v_sub_f32 v111, v111, v53
    v_sub_f32 v112, v112, v53
    v_sub_f32 v113, v113, v53
    v_sub_f32 v114, v114, v53
    v_sub_f32 v115, v115, v53
    v_sub_f32 v116, v116, v53
    v_sub_f32 v117, v117, v53
    v_sub_f32 v118, v118, v53
    v_sub_f32 v119, v119, v53
    v_sub_f32 v120, v120, v53
    v_sub_f32 v121, v121, v53
    v_sub_f32 v122, v122, v53
    v_sub_f32 v123, v123, v53
    v_sub_f32 v124, v124, v53
    v_sub_f32 v125, v125, v53
    v_sub_f32 v126, v126, v53
    v_sub_f32 v127, v127, v53
    v_sub_f32 v128, v128, v53
    v_sub_f32 v129, v129, v53
    v_sub_f32 v130, v130, v53
    v_sub_f32 v131, v131, v53
    v_sub_f32 v132, v132, v53
    v_sub_f32 v133, v133, v53
    v_sub_f32 v134, v134, v53
    v_sub_f32 v135, v135, v53
    s_cmp_eq_u32 s60, 0
    s_cbranch_scc0 wsk_138
    v_add_f32_dpp v56, v104, v104 row_ror:8 row_mask:0xf bank_mask:0xf
    v_add_f32_dpp v57, v105, v105 row_ror:8 row_mask:0xf bank_mask:0xf
    v_add_f32_dpp v58, v106, v106 row_ror:8 row_mask:0xf bank_mask:0xf
    v_add_f32_dpp v59, v107, v107 row_ror:8 row_mask:0xf bank_mask:0xf
    v_add_f32_dpp v60, v108, v108 row_ror:8 row_mask:0xf bank_mask:0xf
    v_add_f32_dpp v61, v109, v109 row_ror:8 row_mask:0xf bank_mask:0xf
    v_add_f32_dpp v62, v110, v110 row_ror:8 row_mask:0xf bank_mask:0xf
    v_add_f32_dpp v63, v111, v111 row_ror:8 row_mask:0xf bank_mask:0xf
    v_add_f32_dpp v64, v112, v112 row_ror:8 row_mask:0xf bank_mask:0xf
    v_add_f32_dpp v65, v113, v113 row_ror:8 row_mask:0xf bank_mask:0xf
    v_add_f32_dpp v66, v114, v114 row_ror:8 row_mask:0xf bank_mask:0xf
    v_add_f32_dpp v67, v115, v115 row_ror:8 row_mask:0xf bank_mask:0xf
    v_add_f32_dpp v68, v116, v116 row_ror:8 row_mask:0xf bank_mask:0xf
    v_add_f32_dpp v69, v117, v117 row_ror:8 row_mask:0xf bank_mask:0xf
    v_add_f32_dpp v70, v118, v118 row_ror:8 row_mask:0xf bank_mask:0xf
    v_add_f32_dpp v71, v119, v119 row_ror:8 row_mask:0xf bank_mask:0xf
    v_add_f32_dpp v72, v120, v120 row_ror:8 row_mask:0xf bank_mask:0xf
    v_add_f32_dpp v73, v121, v121 row_ror:8 row_mask:0xf bank_mask:0xf
    v_add_f32_dpp v74, v122, v122 row_ror:8 row_mask:0xf bank_mask:0xf
    v_add_f32_dpp v75, v123, v123 row_ror:8 row_mask:0xf bank_mask:0xf
    v_add_f32_dpp v76, v124, v124 row_ror:8 row_mask:0xf bank_mask:0xf
    v_add_f32_dpp v77, v125, v125 row_ror:8 row_mask:0xf bank_mask:0xf
    v_add_f32_dpp v78, v126, v126 row_ror:8 row_mask:0xf bank_mask:0xf
    v_add_f32_dpp v79, v127, v127 row_ror:8 row_mask:0xf bank_mask:0xf
    v_add_f32_dpp v80, v128, v128 row_ror:8 row_mask:0xf bank_mask:0xf
    v_add_f32_dpp v81, v129, v129 row_ror:8 row_mask:0xf bank_mask:0xf
    v_add_f32_dpp v82, v130, v130 row_ror:8 row_mask:0xf bank_mask:0xf
    v_add_f32_dpp v83, v131, v131 row_ror:8 row_mask:0xf bank_mask:0xf
    v_add_f32_dpp v84, v132, v132 row_ror:8 row_mask:0xf bank_mask:0xf
    v_add_f32_dpp v85, v133, v133 row_ror:8 row_mask:0xf bank_mask:0xf
    v_add_f32_dpp v86, v134, v134 row_ror:8 row_mask:0xf bank_mask:0xf
    v_add_f32_dpp v87, v135, v135 row_ror:8 row_mask:0xf bank_mask:0xf
    v_add_f32_dpp v56, v56, v56 row_ror:4 row_mask:0xf bank_mask:0xf
    v_add_f32_dpp v57, v57, v57 row_ror:4 row_mask:0xf bank_mask:0xf
    v_add_f32_dpp v58, v58, v58 row_ror:4 row_mask:0xf bank_mask:0xf
    v_add_f32_dpp v59, v59, v59 row_ror:4 row_mask:0xf bank_mask:0xf
    v_add_f32_dpp v60, v60, v60 row_ror:4 row_mask:0xf bank_mask:0xf
    v_add_f32_dpp v61, v61, v61 row_ror:4 row_mask:0xf bank_mask:0xf
    v_add_f32_dpp v62, v62, v62 row_ror:4 row_mask:0xf bank_mask:0xf
    v_add_f32_dpp v63, v63, v63 row_ror:4 row_mask:0xf bank_mask:0xf
    v_add_f32_dpp v64, v64, v64 row_ror:4 row_mask:0xf bank_mask:0xf
    v_add_f32_dpp v65, v65, v65 row_ror:4 row_mask:0xf bank_mask:0xf
    v_add_f32_dpp v66, v66, v66 row_ror:4 row_mask:0xf bank_mask:0xf
    v_add_f32_dpp v67, v67, v67 row_ror:4 row_mask:0xf bank_mask:0xf
    v_add_f32_dpp v68, v68, v68 row_ror:4 row_mask:0xf bank_mask:0xf
    v_add_f32_dpp v69, v69, v69 row_ror:4 row_mask:0xf bank_mask:0xf
    v_add_f32_dpp v70, v70, v70 row_ror:4 row_mask:0xf bank_mask:0xf
    v_add_f32_dpp v71, v71, v71 row_ror:4 row_mask:0xf bank_mask:0xf
    v_add_f32_dpp v72, v72, v72 row_ror:4 row_mask:0xf bank_mask:0xf
    v_add_f32_dpp v73, v73, v73 row_ror:4 row_mask:0xf bank_mask:0xf
    v_add_f32_dpp v74, v74, v74 row_ror:4 row_mask:0xf bank_mask:0xf
    v_add_f32_dpp v75, v75, v75 row_ror:4 row_mask:0xf bank_mask:0xf
    v_add_f32_dpp v76, v76, v76 row_ror:4 row_mask:0xf bank_mask:0xf
    v_add_f32_dpp v77, v77, v77 row_ror:4 row_mask:0xf bank_mask:0xf
    v_add_f32_dpp v78, v78, v78 row_ror:4 row_mask:0xf bank_mask:0xf
    v_add_f32_dpp v79, v79, v79 row_ror:4 row_mask:0xf bank_mask:0xf
    v_add_f32_dpp v80, v80, v80 row_ror:4 row_mask:0xf bank_mask:0xf
    v_add_f32_dpp v81, v81, v81 row_ror:4 row_mask:0xf bank_mask:0xf
    v_add_f32_dpp v82, v82, v82 row_ror:4 row_mask:0xf bank_mask:0xf
    v_add_f32_dpp v83, v83, v83 row_ror:4 row_mask:0xf bank_mask:0xf
    v_add_f32_dpp v84, v84, v84 row_ror:4 row_mask:0xf bank_mask:0xf
    v_add_f32_dpp v85, v85, v85 row_ror:4 row_mask:0xf bank_mask:0xf
    v_add_f32_dpp v86, v86, v86 row_ror:4 row_mask:0xf bank_mask:0xf
    v_add_f32_dpp v87, v87, v87 row_ror:4 row_mask:0xf bank_mask:0xf
    v_add_f32_dpp v56, v56, v56 row_ror:2 row_mask:0xf bank_mask:0xf
    v_add_f32_dpp v57, v57, v57 row_ror:2 row_mask:0xf bank_mask:0xf
    v_add_f32_dpp v58, v58, v58 row_ror:2 row_mask:0xf bank_mask:0xf
    v_add_f32_dpp v59, v59, v59 row_ror:2 row_mask:0xf bank_mask:0xf
    v_add_f32_dpp v60, v60, v60 row_ror:2 row_mask:0xf bank_mask:0xf
    v_add_f32_dpp v61, v61, v61 row_ror:2 row_mask:0xf bank_mask:0xf
    v_add_f32_dpp v62, v62, v62 row_ror:2 row_mask:0xf bank_mask:0xf
    v_add_f32_dpp v63, v63, v63 row_ror:2 row_mask:0xf bank_mask:0xf
    v_add_f32_dpp v64, v64, v64 row_ror:2 row_mask:0xf bank_mask:0xf
    v_add_f32_dpp v65, v65, v65 row_ror:2 row_mask:0xf bank_mask:0xf
    v_add_f32_dpp v66, v66, v66 row_ror:2 row_mask:0xf bank_mask:0xf
    v_add_f32_dpp v67, v67, v67 row_ror:2 row_mask:0xf bank_mask:0xf
    v_add_f32_dpp v68, v68, v68 row_ror:2 row_mask:0xf bank_mask:0xf
    v_add_f32_dpp v69, v69, v69 row_ror:2 row_mask:0xf bank_mask:0xf
    v_add_f32_dpp v70, v70, v70 row_ror:2 row_mask:0xf bank_mask:0xf
    v_add_f32_dpp v71, v71, v71 row_ror:2 row_mask:0xf bank_mask:0xf
    v_add_f32_dpp v72, v72, v72 row_ror:2 row_mask:0xf bank_mask:0xf
    v_add_f32_dpp v73, v73, v73 row_ror:2 row_mask:0xf bank_mask:0xf
    v_add_f32_dpp v74, v74, v74 row_ror:2 row_mask:0xf bank_mask:0xf
    v_add_f32_dpp v75, v75, v75 row_ror:2 row_mask:0xf bank_mask:0xf
    v_add_f32_dpp v76, v76, v76 row_ror:2 row_mask:0xf bank_mask:0xf
    v_add_f32_dpp v77, v77, v77 row_ror:2 row_mask:0xf bank_mask:0xf
    v_add_f32_dpp v78, v78, v78 row_ror:2 row_mask:0xf bank_mask:0xf
    v_add_f32_dpp v79, v79, v79 row_ror:2 row_mask:0xf bank_mask:0xf
    v_add_f32_dpp v80, v80, v80 row_ror:2 row_mask:0xf bank_mask:0xf
    v_add_f32_dpp v81, v81, v81 row_ror:2 row_mask:0xf bank_mask:0xf
    v_add_f32_dpp v82, v82, v82 row_ror:2 row_mask:0xf bank_mask:0xf
    v_add_f32_dpp v83, v83, v83 row_ror:2 row_mask:0xf bank_mask:0xf
    v_add_f32_dpp v84, v84, v84 row_ror:2 row_mask:0xf bank_mask:0xf
    v_add_f32_dpp v85, v85, v85 row_ror:2 row_mask:0xf bank_mask:0xf
    v_add_f32_dpp v86, v86, v86 row_ror:2 row_mask:0xf bank_mask:0xf
    v_add_f32_dpp v87, v87, v87 row_ror:2 row_mask:0xf bank_mask:0xf
    v_add_f32_dpp v56, v56, v56 row_ror:1 row_mask:0xf bank_mask:0xf
    v_add_f32_dpp v57, v57, v57 row_ror:1 row_mask:0xf bank_mask:0xf
    v_add_f32_dpp v58, v58, v58 row_ror:1 row_mask:0xf bank_mask:0xf
    v_add_f32_dpp v59, v59, v59 row_ror:1 row_mask:0xf bank_mask:0xf
    v_add_f32_dpp v60, v60, v60 row_ror:1 row_mask:0xf bank_mask:0xf
    v_add_f32_dpp v61, v61, v61 row_ror:1 row_mask:0xf bank_mask:0xf
    v_add_f32_dpp v62, v62, v62 row_ror:1 row_mask:0xf bank_mask:0xf
    v_add_f32_dpp v63, v63, v63 row_ror:1 row_mask:0xf bank_mask:0xf
    v_add_f32_dpp v64, v64, v64 row_ror:1 row_mask:0xf bank_mask:0xf
    v_add_f32_dpp v65, v65, v65 row_ror:1 row_mask:0xf bank_mask:0xf
    v_add_f32_dpp v66, v66, v66 row_ror:1 row_mask:0xf bank_mask:0xf
    v_add_f32_dpp v67, v67, v67 row_ror:1 row_mask:0xf bank_mask:0xf
    v_add_f32_dpp v68, v68, v68 row_ror:1 row_mask:0xf bank_mask:0xf
    v_add_f32_dpp v69, v69, v69 row_ror:1 row_mask:0xf bank_mask:0xf
    v_add_f32_dpp v70, v70, v70 row_ror:1 row_mask:0xf bank_mask:0xf
    v_add_f32_dpp v71, v71, v71 row_ror:1 row_mask:0xf bank_mask:0xf
    v_add_f32_dpp v72, v72, v72 row_ror:1 row_mask:0xf bank_mask:0xf
    v_add_f32_dpp v73, v73, v73 row_ror:1 row_mask:0xf bank_mask:0xf
    v_add_f32_dpp v74, v74, v74 row_ror:1 row_mask:0xf bank_mask:0xf
    v_add_f32_dpp v75, v75, v75 row_ror:1 row_mask:0xf bank_mask:0xf
    v_add_f32_dpp v76, v76, v76 row_ror:1 row_mask:0xf bank_mask:0xf
    v_add_f32_dpp v77, v77, v77 row_ror:1 row_mask:0xf bank_mask:0xf
    v_add_f32_dpp v78, v78, v78 row_ror:1 row_mask:0xf bank_mask:0xf
    v_add_f32_dpp v79, v79, v79 row_ror:1 row_mask:0xf bank_mask:0xf
    v_add_f32_dpp v80, v80, v80 row_ror:1 row_mask:0xf bank_mask:0xf
    v_add_f32_dpp v81, v81, v81 row_ror:1 row_mask:0xf bank_mask:0xf
    v_add_f32_dpp v82, v82, v82 row_ror:1 row_mask:0xf bank_mask:0xf
    v_add_f32_dpp v83, v83, v83 row_ror:1 row_mask:0xf bank_mask:0xf
    v_add_f32_dpp v84, v84, v84 row_ror:1 row_mask:0xf bank_mask:0xf
    v_add_f32_dpp v85, v85, v85 row_ror:1 row_mask:0xf bank_mask:0xf
    v_add_f32_dpp v86, v86, v86 row_ror:1 row_mask:0xf bank_mask:0xf
    v_add_f32_dpp v87, v87, v87 row_ror:1 row_mask:0xf bank_mask:0xf
    v_lshlrev_b32 v55, 4, v50
    v_add_u32 v55, 73728, v55
    s_mov_b32 exec_lo, 0x00010001
    s_mov_b32 exec_hi, 0x00010001
    ds_add_f32 v55, v56 offset:0
    ds_add_f32 v55, v57 offset:4
    ds_add_f32 v55, v58 offset:8
    ds_add_f32 v55, v59 offset:12
    ds_add_f32 v55, v60 offset:64
    ds_add_f32 v55, v61 offset:68
    ds_add_f32 v55, v62 offset:72
    ds_add_f32 v55, v63 offset:76
    ds_add_f32 v55, v64 offset:128
    ds_add_f32 v55, v65 offset:132
    ds_add_f32 v55, v66 offset:136
    ds_add_f32 v55, v67 offset:140
    ds_add_f32 v55, v68 offset:192
    ds_add_f32 v55, v69 offset:196
    ds_add_f32 v55, v70 offset:200
    ds_add_f32 v55, v71 offset:204
    ds_add_f32 v55, v72 offset:256
    ds_add_f32 v55, v73 offset:260
    ds_add_f32 v55, v74 offset:264
    ds_add_f32 v55, v75 offset:268
    ds_add_f32 v55, v76 offset:320
    ds_add_f32 v55, v77 offset:324
    ds_add_f32 v55, v78 offset:328
    ds_add_f32 v55, v79 offset:332
    ds_add_f32 v55, v80 offset:384
    ds_add_f32 v55, v81 offset:388
    ds_add_f32 v55, v82 offset:392
    ds_add_f32 v55, v83 offset:396
    ds_add_f32 v55, v84 offset:448
    ds_add_f32 v55, v85 offset:452
    ds_add_f32 v55, v86 offset:456
    ds_add_f32 v55, v87 offset:460
    s_mov_b64 exec, -1
    s_waitcnt lgkmcnt(0)
wsk_138:
    s_barrier
    s_cmp_ge_u32 s6, 8
    s_cbranch_scc1 wfin_139
    s_cmp_eq_u32 s60, 0
    s_cbranch_scc0 wc_140
    ds_read_b128 v[56:59], v55 offset:0
    ds_read_b128 v[60:63], v55 offset:64
    ds_read_b128 v[64:67], v55 offset:128
    ds_read_b128 v[68:71], v55 offset:192
    ds_read_b128 v[72:75], v55 offset:256
    ds_read_b128 v[76:79], v55 offset:320
    ds_read_b128 v[80:83], v55 offset:384
    ds_read_b128 v[84:87], v55 offset:448
    s_mov_b32 s70, 0xbc000000
    s_mov_b32 s71, 0x3e0293ee
    s_waitcnt lgkmcnt(0)
    v_fma_f32 v104, v56, s70, v104
    v_fma_f32 v105, v57, s70, v105
    v_fma_f32 v106, v58, s70, v106
    v_fma_f32 v107, v59, s70, v107
    v_fma_f32 v108, v60, s70, v108
    v_fma_f32 v109, v61, s70, v109
    v_fma_f32 v110, v62, s70, v110
    v_fma_f32 v111, v63, s70, v111
    v_fma_f32 v112, v64, s70, v112
    v_fma_f32 v113, v65, s70, v113
    v_fma_f32 v114, v66, s70, v114
    v_fma_f32 v115, v67, s70, v115
    v_fma_f32 v116, v68, s70, v116
    v_fma_f32 v117, v69, s70, v117
    v_fma_f32 v118, v70, s70, v118
    v_fma_f32 v119, v71, s70, v119
    v_fma_f32 v120, v72, s70, v120
    v_fma_f32 v121, v73, s70, v121
    v_fma_f32 v122, v74, s70, v122
    v_fma_f32 v123, v75, s70, v123
    v_fma_f32 v124, v76, s70, v124
    v_fma_f32 v125, v77, s70, v125
    v_fma_f32 v126, v78, s70, v126
    v_fma_f32 v127, v79, s70, v127
    v_fma_f32 v128, v80, s70, v128
    v_fma_f32 v129, v81, s70, v129
    v_fma_f32 v130, v82, s70, v130
    v_fma_f32 v131, v83, s70, v131
    v_fma_f32 v132, v84, s70, v132
    v_fma_f32 v133, v85, s70, v133
    v_fma_f32 v134, v86, s70, v134
    v_fma_f32 v135, v87, s70, v135
    v_mul_f32 v104, s71, v104
    v_mul_f32 v105, s71, v105
    v_mul_f32 v106, s71, v106
    v_mul_f32 v107, s71, v107
    v_mul_f32 v108, s71, v108
    v_mul_f32 v109, s71, v109
    v_mul_f32 v110, s71, v110
    v_mul_f32 v111, s71, v111
    v_mul_f32 v112, s71, v112
    v_mul_f32 v113, s71, v113
    v_mul_f32 v114, s71, v114
    v_mul_f32 v115, s71, v115
    v_mul_f32 v116, s71, v116
    v_mul_f32 v117, s71, v117
    v_mul_f32 v118, s71, v118
    v_mul_f32 v119, s71, v119
    v_mul_f32 v120, s71, v120
    v_mul_f32 v121, s71, v121
    v_mul_f32 v122, s71, v122
    v_mul_f32 v123, s71, v123
    v_mul_f32 v124, s71, v124
    v_mul_f32 v125, s71, v125
    v_mul_f32 v126, s71, v126
    v_mul_f32 v127, s71, v127
    v_mul_f32 v128, s71, v128
    v_mul_f32 v129, s71, v129
    v_mul_f32 v130, s71, v130
    v_mul_f32 v131, s71, v131
    v_mul_f32 v132, s71, v132
    v_mul_f32 v133, s71, v133
    v_mul_f32 v134, s71, v134
    v_mul_f32 v135, s71, v135
wc_140:
    s_lshl_b32 s68, s6, 12
    s_lshl_b32 s69, s60, 15
    s_add_u32 s68, s68, s69
    s_add_u32 s70, s4, s68
    s_addc_u32 s71, s5, 0
    s_add_u32 s70, s70, 196608
    s_addc_u32 s71, s71, 0
    v_cvt_pk_bf16_f32 v56, v104, v105
    v_cvt_pk_bf16_f32 v57, v106, v107
    v_cvt_pk_bf16_f32 v58, v108, v109
    v_cvt_pk_bf16_f32 v59, v110, v111
    global_store_dwordx4 v2, v[56:59], s[70:71] offset:0 sc1
    v_cvt_pk_bf16_f32 v60, v112, v113
    v_cvt_pk_bf16_f32 v61, v114, v115
    v_cvt_pk_bf16_f32 v62, v116, v117
    v_cvt_pk_bf16_f32 v63, v118, v119
    global_store_dwordx4 v2, v[60:63], s[70:71] offset:1024 sc1
    v_cvt_pk_bf16_f32 v64, v120, v121
    v_cvt_pk_bf16_f32 v65, v122, v123
    v_cvt_pk_bf16_f32 v66, v124, v125
    v_cvt_pk_bf16_f32 v67, v126, v127
    global_store_dwordx4 v2, v[64:67], s[70:71] offset:2048 sc1
    v_cvt_pk_bf16_f32 v68, v128, v129
    v_cvt_pk_bf16_f32 v69, v130, v131
    v_cvt_pk_bf16_f32 v70, v132, v133
    v_cvt_pk_bf16_f32 v71, v134, v135
    global_store_dwordx4 v2, v[68:71], s[70:71] offset:3072 sc1
wfin_139:
    s_waitcnt vmcnt(0)
    s_barrier
    s_cmp_eq_u32 s6, 0
    s_cbranch_scc0 sk_143
    s_sub_u32 s27, s2, 254
    s_lshl_b32 s27, s27, 7
    s_add_u32 s27, s27, 57344
    v_mov_b32 v20, s27
    v_mov_b32 v21, s53
    s_mov_b64 exec, 1
    global_store_dword v20, v21, s[4:5] sc1
    s_mov_b64 exec, -1
sk_143:
    s_branch k_h1
ovf_1:
    s_mul_i32 s79, s2, 10240
    s_add_u32 s79, s79, 33554432
    s_mov_b64 exec, s[74:75]
    v_cmp_le_u32 vcc, 56, v72
    s_nop 0
    s_and_b64 exec, exec, vcc
    s_cbranch_execz ovs_144
    ds_add_rtn_u32 v76, v79, v51
    s_waitcnt lgkmcnt(0)
    v_lshl_add_u32 v76, v76, 2, s79
    global_store_dword v76, v56, s[4:5] sc1
ovs_144:
    s_mov_b64 exec, s[74:75]
    v_cmp_le_u32 vcc, 56, v73
    s_nop 0
    s_and_b64 exec, exec, vcc
    s_cbranch_execz ovs_145
    ds_add_rtn_u32 v76, v79, v51
    s_waitcnt lgkmcnt(0)
    v_lshl_add_u32 v76, v76, 2, s79
    global_store_dword v76, v57, s[4:5] sc1
ovs_145:
    s_mov_b64 exec, s[74:75]
    v_cmp_le_u32 vcc, 56, v74
    s_nop 0
    s_and_b64 exec, exec, vcc
    s_cbranch_execz ovs_146
    ds_add_rtn_u32 v76, v79, v51
    s_waitcnt lgkmcnt(0)
    v_lshl_add_u32 v76, v76, 2, s79
    global_store_dword v76, v58, s[4:5] sc1
ovs_146:
    s_mov_b64 exec, s[74:75]
    v_cmp_le_u32 vcc, 56, v75
    s_nop 0
    s_and_b64 exec, exec, vcc
    s_cbranch_execz ovs_147
    ds_add_rtn_u32 v76, v79, v51
    s_waitcnt lgkmcnt(0)
    v_lshl_add_u32 v76, v76, 2, s79
    global_store_dword v76, v59, s[4:5] sc1
ovs_147:
    s_branch ovb_2
lt_23:
    v_lshrrev_b32 v84, 16, v60
    v_lshrrev_b32 v85, 16, v61
    v_lshrrev_b32 v86, 16, v62
    v_lshrrev_b32 v87, 16, v63
    v_lshlrev_b32 v84, 3, v84
    v_lshlrev_b32 v85, 3, v85
    v_lshlrev_b32 v86, 3, v86
    v_lshlrev_b32 v87, 3, v87
    v_cmpx_ne_u32 s[72:73], -1, v60
    ds_add_rtn_u32 v88, v55, v52
    ds_add_u32 v84, v52 offset:51200
    v_cmpx_ne_u32 s[74:75], -1, v61
    ds_add_rtn_u32 v89, v55, v52
    ds_add_u32 v85, v52 offset:51200
    v_cmpx_ne_u32 s[76:77], -1, v62
    ds_add_rtn_u32 v90, v55, v52
    ds_add_u32 v86, v52 offset:51200
    v_cmpx_ne_u32 s[78:79], -1, v63
    ds_add_rtn_u32 v91, v55, v52
    ds_add_u32 v87, v52 offset:51200
    s_waitcnt lgkmcnt(0)
    s_mov_b64 exec, s[78:79]
    v_lshlrev_b32 v91, 2, v91
    ds_write_b32 v91, v63 offset:51840
    s_mov_b64 exec, s[76:77]
    v_lshlrev_b32 v90, 2, v90
    ds_write_b32 v90, v62 offset:51840
    s_mov_b64 exec, s[74:75]
    v_lshlrev_b32 v89, 2, v89
    ds_write_b32 v89, v61 offset:51840
    s_mov_b64 exec, s[72:73]
    v_lshlrev_b32 v88, 2, v88
    ds_write_b32 v88, v60 offset:51840
    s_mov_b64 exec, -1
    s_and_b64 s[66:67], s[66:67], s[78:79]
    s_cbranch_scc0 ltb_24
    v_add_u32 v51, 16, v51
    v_add_u32 v50, 1, v50
    v_cmp_gt_u32 vcc, 8, v50
    s_nop 0
    s_and_b64 s[66:67], s[66:67], vcc
    s_cbranch_scc0 ltb_24
    s_waitcnt lgkmcnt(0)
    v_mov_b32 v60, -1
    v_mov_b32 v61, -1
    v_mov_b32 v62, -1
    v_mov_b32 v63, -1
    s_mov_b64 exec, s[66:67]
    global_load_dwordx4 v[60:63], v51, s[60:61] offset:96 sc1
    s_mov_b64 exec, -1
    s_waitcnt vmcnt(0)
    s_branch lt_23
spl_32:
    s_mov_b64 exec, vcc
    v_mov_b32 v73, 0x10000
    ds_add_rtn_u32 v73, v57, v73 offset:51200
    s_lshl_b32 s3, s76, 2
    s_waitcnt lgkmcnt(0)
    v_lshrrev_b32 v73, 16, v73
    v_add_u32 v70, s3, v73
    v_lshl_add_u32 v72, v70, 1, v62
    v_min_u32 v73, 59, v70
    v_lshrrev_b32 v73, 2, v73
    v_add_u32 v73, 1, v73
    ds_max_u32 v55, v73 offset:12
    v_cmp_le_u32 vcc, 60, v70
    s_cbranch_vccz nsp_148
    s_andn2_b64 s[86:87], s[86:87], vcc
    s_mov_b64 exec, vcc
    ds_add_rtn_u32 v73, v55, v52 offset:4
    s_lshl_b32 s3, s89, 15
    s_add_u32 s3, s3, 34865152
    s_lshl_b32 s74, s89, 22
    v_or_b32 v56, s74, v56
    s_waitcnt lgkmcnt(0)
    v_and_b32 v73, 0xffff, v73
    v_lshl_add_u32 v73, v73, 2, s3
    global_store_dword v73, v56, s[4:5] sc1
    s_waitcnt vmcnt(0)
nsp_148:
    s_mov_b64 exec, s[86:87]
    s_branch spb_33
more_34:
    s_sub_u32 s71, s71, 768
    v_add_u32 v90, 768, v90
    v_lshlrev_b32 v54, 2, v90
    ds_read_b32 v56, v54 offset:51840
    v_cmp_gt_u32 s[86:87], s71, v48
    v_mov_b32 v63, 0x10000
    s_waitcnt lgkmcnt(0)
    v_bfe_u32 v62, v56, 16, 6
    v_lshlrev_b32 v57, 3, v62
    v_mul_u32_u24 v62, 144, v62
    v_cmp_gt_u16 vcc, s68, v56
    s_mov_b64 exec, s[86:87]
    ds_add_rtn_u32 v60, v57, v63 offset:51204
    v_cndmask_b32 v61, v63, 1, vcc
    s_waitcnt lgkmcnt(0)
    v_lshrrev_b32 v67, 16, v60
    v_add_u32 v67, v67, v60
    v_cndmask_b32 v60, v60, v67, vcc
    s_mov_b64 exec, -1
    s_branch fl_28
sp_54:
    s_cmp_lg_u32 s32, 0
    s_cbranch_scc0 sk_149
    s_add_u32 s34, s11, 0
    s_mov_b32 s35, 0
    s_call_b64 s[30:31], k_slow
sk_149:
    s_nop 7
    v_mul_f32 v16, v4, v13
    v_mul_f32 v17, v5, v13
    v_mul_f32 v18, v6, v13
    v_mul_f32 v19, v7, v13
    s_cmp_eq_u32 s18, 7
    s_cbranch_scc1 tok_55
    v_mul_f32 v20, v16, v13
    v_mul_f32 v21, v17, v13
    v_mul_f32 v22, v18, v13
    v_mul_f32 v23, v19, v13
    v_cvt_pk_bf16_f32 v24, v20, v21
    v_cvt_pk_bf16_f32 v25, v22, v23
    s_nop 0
    v_mov_b32_dpp v26, v24 quad_perm:[1,1,3,3] row_mask:0xf bank_mask:0xf
    v_mov_b32_dpp v27, v25 quad_perm:[1,1,3,3] row_mask:0xf bank_mask:0xf
    s_mov_b64 exec, s[22:23]
    global_store_dwordx4 v0, v[24:27], s[54:55] sc1
    s_mov_b64 exec, -1
    s_branch tok_55
fs_65:
    global_store_dword v2, v3, s[38:39] offset:0 sc1
    s_branch fd_66
em_56:
    v_mov_b32 v4, 0
    v_mov_b32 v5, 0
    v_mov_b32 v6, 0
    v_mov_b32 v7, 0
    s_add_u32 s54, s54, 40960
    s_addc_u32 s55, s55, 0
    s_cmp_eq_u32 s18, 7
    s_cbranch_scc1 h7_150
    s_mov_b64 exec, 1
    s_cmp_eq_u32 s21, 0
    s_waitcnt vmcnt(0)
    s_cbranch_scc1 fs_152
    global_store_dword v2, v3, s[38:39] offset:0
fd_153:
    s_mov_b64 exec, -1
hb_151:
    s_branch eb_57
sp_67:
    s_cmp_lg_u32 s33, 0
    s_cbranch_scc0 sk_154
    s_add_u32 s34, s11, 80
    s_mov_b32 s35, 0
    s_call_b64 s[30:31], k_slow
sk_154:
    s_nop 7
    v_mul_f32 v16, v4, v14
    v_mul_f32 v17, v5, v14
    v_mul_f32 v18, v6, v14
    v_mul_f32 v19, v7, v14
    s_cmp_eq_u32 s18, 7
    s_cbranch_scc1 tok_68
    v_mul_f32 v20, v16, v14
    v_mul_f32 v21, v17, v14
    v_mul_f32 v22, v18, v14
    v_mul_f32 v23, v19, v14
    v_cvt_pk_bf16_f32 v24, v20, v21
    v_cvt_pk_bf16_f32 v25, v22, v23
    s_nop 0
    v_mov_b32_dpp v26, v24 quad_perm:[1,1,3,3] row_mask:0xf bank_mask:0xf
    v_mov_b32_dpp v27, v25 quad_perm:[1,1,3,3] row_mask:0xf bank_mask:0xf
    s_mov_b64 exec, s[22:23]
    global_store_dwordx4 v0, v[24:27], s[54:55] sc1
    s_mov_b64 exec, -1
    s_branch tok_68
fs_69:
    global_store_dword v2, v3, s[38:39] offset:160 sc1
    s_branch fd_70
sp_81:
    s_cmp_lg_u32 s32, 0
    s_cbranch_scc0 sk_155
    s_add_u32 s34, s11, 0
    s_mov_b32 s35, 40960
    s_call_b64 s[30:31], k_slow
sk_155:
    s_nop 7
    v_mul_f32 v16, v4, v13
    v_mul_f32 v17, v5, v13
    v_mul_f32 v18, v6, v13
    v_mul_f32 v19, v7, v13
    v_mul_f32 v20, v16, v13
    v_mul_f32 v21, v17, v13
    v_mul_f32 v22, v18, v13
    v_mul_f32 v23, v19, v13
    v_cvt_pk_bf16_f32 v24, v20, v21
    v_cvt_pk_bf16_f32 v25, v22, v23
    s_nop 0
    v_mov_b32_dpp v26, v24 quad_perm:[1,1,3,3] row_mask:0xf bank_mask:0xf
    v_mov_b32_dpp v27, v25 quad_perm:[1,1,3,3] row_mask:0xf bank_mask:0xf
    s_mov_b64 exec, s[22:23]
    global_store_dwordx4 v0, v[24:27], s[54:55] sc1
    s_mov_b64 exec, -1
    s_branch tok_82
fs_90:
    global_store_dword v2, v3, s[38:39] offset:0 sc1
    s_branch fd_91
em_83:
    v_mov_b32 v4, 0
    v_mov_b32 v5, 0
    v_mov_b32 v6, 0
    v_mov_b32 v7, 0
    s_add_u32 s54, s54, 40960
    s_addc_u32 s55, s55, 0
    s_mov_b64 exec, 1
    s_cmp_eq_u32 s21, 0
    s_waitcnt vmcnt(0)
    s_cbranch_scc1 fs_156
    global_store_dword v2, v3, s[38:39] offset:0
fd_157:
    s_mov_b64 exec, -1
    s_branch eb_84
sp_92:
    s_cmp_lg_u32 s33, 0
    s_cbranch_scc0 sk_158
    s_add_u32 s34, s11, 80
    s_mov_b32 s35, 40960
    s_call_b64 s[30:31], k_slow
sk_158:
    s_nop 7
    v_mul_f32 v16, v4, v14
    v_mul_f32 v17, v5, v14
    v_mul_f32 v18, v6, v14
    v_mul_f32 v19, v7, v14
    v_mul_f32 v20, v16, v14
    v_mul_f32 v21, v17, v14
    v_mul_f32 v22, v18, v14
    v_mul_f32 v23, v19, v14
    v_cvt_pk_bf16_f32 v24, v20, v21
    v_cvt_pk_bf16_f32 v25, v22, v23
    s_nop 0
    v_mov_b32_dpp v26, v24 quad_perm:[1,1,3,3] row_mask:0xf bank_mask:0xf
    v_mov_b32_dpp v27, v25 quad_perm:[1,1,3,3] row_mask:0xf bank_mask:0xf
    s_mov_b64 exec, s[22:23]
    global_store_dwordx4 v0, v[24:27], s[54:55] sc1
    s_mov_b64 exec, -1
    s_branch tok_93
fs_94:
    global_store_dword v2, v3, s[38:39] offset:160 sc1
    s_branch fd_95
k_wf:
    s_branch se_161
sp_159:
    s_sleep 4
se_161:
    global_load_dword v42, v40, s[4:5] sc1
    global_load_dword v43, v41, s[4:5] sc1
    s_add_u32 s19, s19, 1
    s_cmp_ge_u32 s19, 4194304
    s_cbranch_scc1 so_160
    s_waitcnt vmcnt(0)
    v_xor_b32 v42, s53, v42
    v_xor_b32 v43, s53, v43
    v_or_b32 v42, v42, v43
    v_cmp_ne_u32 vcc, 0, v42
    s_cbranch_vccnz sp_159
so_160:
    s_waitcnt vmcnt(0)
    s_sub_u32 s27, s6, 8
k_wfl:
    s_lshl_b32 s28, s27, 10
    s_add_u32 s16, s12, s28
    s_addc_u32 s17, s13, 0
    s_cmp_lt_u32 s27, 40
    s_cselect_b32 s29, 122880, 0
    s_add_u32 s28, s28, s29
    s_sub_u32 m0, s28, 40960
    s_add_u32 s27, s27, 4
    global_load_lds_dwordx4 v2, s[16:17] sc1
    s_cmp_lt_u32 s27, 79
    s_cbranch_scc1 k_wfl
    s_branch wsk_138
fs_152:
    global_store_dword v2, v3, s[38:39] offset:0 sc1
    s_branch fd_153
fs_156:
    global_store_dword v2, v3, s[38:39] offset:0 sc1
    s_branch fd_157
h7_63:
    s_call_b64 s[30:31], k_w7
    s_branch hb_64
h7_150:
    s_call_b64 s[30:31], k_w7
    s_branch hb_151
k_w7:
    s_cmp_lt_u32 s6, 8
    s_cbranch_scc0 k_w7e
    s_lshl_b32 s27, s6, 13
    s_add_u32 s16, s4, s27
    s_addc_u32 s17, s5, 0
    s_add_u32 s16, s16, 200704
    s_addc_u32 s17, s17, 0
    global_load_dwordx4 v[48:51], v2, s[16:17] offset:-4096 sc1
    global_load_dwordx4 v[52:55], v2, s[16:17] offset:-3072 sc1
    global_load_dwordx4 v[56:59], v2, s[16:17] offset:-2048 sc1
    global_load_dwordx4 v[60:63], v2, s[16:17] offset:-1024 sc1
    global_load_dwordx4 v[64:67], v2, s[16:17] offset:0 sc1
    global_load_dwordx4 v[68:71], v2, s[16:17] offset:1024 sc1
    global_load_dwordx4 v[72:75], v2, s[16:17] offset:2048 sc1
    global_load_dwordx4 v[76:79], v2, s[16:17] offset:3072 sc1
k_w7e:
    s_setpc_b64 s[30:31]
k_slow:
    s_mov_b32 s40, -1
    v_lshrrev_b32 v24, 4, v2
    v_mov_b32 v28, 0x80000
    v_mov_b32 v18, 0
    v_mov_b32 v19, 0
    v_mov_b32 v20, 0
    v_mov_b32 v21, 0
    v_mov_b32 v22, 0
    v_mov_b32 v23, 0
k_sl_list:
    s_lshl_b32 s41, s34, 7
    s_add_u32 s41, s41, 36868
    s_lshl_b32 s42, s40, 7
    s_add_u32 s42, s42, 4100
    s_lshl_b32 s43, s34, 15
    s_add_u32 s43, s43, 34865152
    s_mul_i32 s44, s40, 10240
    s_add_u32 s44, s44, 33554432
    s_cmp_eq_u32 s40, -1
    s_cselect_b32 s41, s41, s42
    s_cselect_b32 s43, s43, s44
    v_mov_b32 v25, s41
    global_load_dword v25, v25, s[4:5] sc1
    s_mov_b32 s45, 0
    s_waitcnt vmcnt(0)
    v_readfirstlane_b32 s44, v25
    s_nop 0
    s_bfe_u32 s41, s44, 0x100008
    s_cmp_eq_u32 s40, -1
    s_cselect_b32 s44, s41, s44
k_sl_chunk:
    s_cmp_ge_u32 s45, s44
    s_cbranch_scc1 k_sl_next
    v_add_u32 v25, s45, v24
    v_lshl_add_u32 v26, v25, 2, s43
    global_load_dword v26, v26, s[4:5] sc1
    v_cmp_gt_u32 s[46:47], s44, v25
    s_waitcnt vmcnt(0)
    v_lshrrev_b32 v27, 22, v26
    v_cmp_eq_u32 vcc, s34, v27
    s_nop 0
    s_and_b64 s[46:47], s[46:47], vcc
k_sl_bit:
    s_cmp_eq_u64 s[46:47], 0
    s_cbranch_scc1 k_sl_cdone
    s_ff1_i32_b64 s41, s[46:47]
    s_bitset0_b64 s[46:47], s41
    v_readlane_b32 s42, v26, s41
    s_nop 3
    s_bfe_u32 s41, s42, 0x60010
    s_and_b32 s42, s42, 0xffff
    s_lshl_b32 s42, s42, 3
    s_add_u32 s42, s42, s35
    v_mov_b32 v27, s42
    v_cmp_eq_u32 vcc, s41, v24
    s_nop 1
    v_cndmask_b32 v27, v28, v27, vcc
    ds_read_b64 v[16:17], v27
    s_waitcnt lgkmcnt(0)
    v_smfmac_f32_16x16x64_bf16 v[4:7], v[8:11], v[16:23], v12
    s_nop 7
    s_branch k_sl_bit
k_sl_cdone:
    s_add_u32 s45, s45, 64
    s_branch k_sl_chunk
k_sl_next:
    s_add_u32 s40, s40, 1
    s_cmp_lt_u32 s40, 128
    s_cbranch_scc1 k_sl_list
    s_setpc_b64 s[30:31]
k_end:
    s_endpgm
.section .rodata,"a"
.p2align 6
.amdhsa_kernel gather_scatter__hybrid_graph_tf_nagphormer__graph_kernel
  .amdhsa_next_free_vgpr 168
  .amdhsa_next_free_sgpr 102
  .amdhsa_accum_offset 168
  .amdhsa_group_segment_fixed_size 0
  .amdhsa_kernarg_size 96
  .amdhsa_user_sgpr_count 2
  .amdhsa_user_sgpr_kernarg_segment_ptr 1
  .amdhsa_system_sgpr_workgroup_id_x 1
  .amdhsa_float_denorm_mode_32 3
.end_amdhsa_kernel
```
